```python
import torch

def _softmax(x, axis=-1):
    return torch.softmax(x, dim=axis)
def _gelu(x):
    return torch.nn.functional.gelu(x, approximate="tanh")
def _silu(x):
    return torch.nn.functional.silu(x)
def _sigmoid(x):
    return torch.sigmoid(x)
def _layernorm(x, axis=-1, eps=1e-5):
    m = x.mean(dim=axis, keepdim=True)
    v = x.var(dim=axis, keepdim=True, unbiased=False)
    return (x - m) / torch.sqrt(v + eps)
def _scatter_add(tgt, idx, src, axis=0):
    return tgt.clone().index_add_(axis, idx, src)
def _segment_sum(src, seg, n):
    out = torch.zeros((n,) + src.shape[1:], dtype=src.dtype)
    return out.index_add_(0, seg, src)
def _pad(x, pw):
    flat = tuple(v for pair in reversed(pw) for v in pair)
    return torch.nn.functional.pad(x, flat)

kernel_name = 'sequential_preLN__linear_attn_block__dense_activation_silu__prompt'

def setup_inputs():

    _w = (lambda a: (lambda t: t.to(torch.bfloat16) if t.is_floating_point() else t)(torch.as_tensor(a)))
    def _A_setup():
        B, S, D = 1, 2048, 512
        return {
            "x": _w((lambda *s: torch.randn(*s, dtype=torch.bfloat16) * 0.05)(B, S, D)),
            "wqkv": _w((lambda *s: torch.randn(*s, dtype=torch.bfloat16) * 0.05)(D, 3 * D)),
            "wo": _w((lambda *s: torch.randn(*s, dtype=torch.bfloat16) * 0.05)(D, D)),
        }
    _A_in = _A_setup()

    def _B_setup():
        B, S, D, F = 1, 2048, 512, 1792
        return {
            "x": _w((lambda *s: torch.randn(*s, dtype=torch.bfloat16) * 0.05)(B, S, D)),
            "w1": _w((lambda *s: torch.randn(*s, dtype=torch.bfloat16) * 0.8)(D, F) * (D ** -0.5)),
            "w2": _w((lambda *s: torch.randn(*s, dtype=torch.bfloat16) * 0.1)(F, D) * (F ** -0.5)),
        }
    _B_in = _B_setup()

    return {
        "A_x": _A_in["x"],
        "A_wqkv": _A_in["wqkv"],
        "A_wo": _A_in["wo"],
        "B_x": _B_in["x"],
        "B_w1": _B_in["w1"],
        "B_w2": _B_in["w2"],
    }

def reference(A_x, A_wqkv, A_wo, B_x, B_w1, B_w2):
    def _A_ref(x, wqkv, wo):
        B, S, D = x.shape
        H = 32; Dh = D // H
        qkv = (lambda x, *d: x.permute(*d))((x @ wqkv).reshape(B, S, 3, H, Dh), 2, 0, 3, 1, 4)
        q, k, v = qkv[0], qkv[1], qkv[2]
        phi = lambda t: torch.where(t > 0, t + 1, torch.exp(t)) + 1e-6
        pq, pk = phi(q), phi(k)
        kv = torch.einsum("bhsd,bhse->bhde", pk, v)
        z = torch.einsum("bhsd->bhd", pk)
        num = torch.einsum("bhqd,bhde->bhqe", pq, kv)
        den = torch.einsum("bhqd,bhd->bhq", pq, z)[..., None] + 1e-6
        o = num / den
        return (lambda x, *d: x.permute(*d))(o, 0, 2, 1, 3).reshape(B, S, D) @ wo

    def _B_ref(x, w1, w2):
        h = torch.einsum("bsd,df->bsf", x, w1)
        h = _silu(h)
        out = torch.einsum("bsf,fd->bsd", h, w2)
        return out

    x = A_x
    h = x + _A_ref(_layernorm(x, axis=-1), A_wqkv, A_wo)
    h2 = h + _B_ref(_layernorm(h, axis=-1), B_w1, B_w2)
    return h2
```

```asm
; @launch kernel=p1_kernel grid=(228,1,1) block=(512,1,1) lds=135168
; @launch kernel=p2_kernel grid=(256,1,1) block=(256,1,1) lds=65536
; @launch kernel=p3_kernel grid=(224,1,1) block=(512,1,1) lds=135168
; @launch kernel=p4_kernel grid=(256,1,1) block=(256,1,1) lds=65536
.amdgcn_target "amdgcn-amd-amdhsa--gfx950"
.text
.globl p1_kernel
.p2align 8
.type p1_kernel,@function
p1_kernel:
  s_cmp_ge_u32 s2, 228
  s_cbranch_scc1 P1_END
  s_load_dwordx4 s[40:43], s[0:1], 0
  s_load_dwordx2 s[44:45], s[0:1], 16
  s_load_dwordx2 s[46:47], s[0:1], 40
  s_load_dwordx4 s[48:51], s[0:1], 56
  v_and_b32 v1, 63, v0
  v_lshrrev_b32 v2, 6, v0
  s_nop 0
  v_readfirstlane_b32 s3, v2
  s_and_b32 s37, s3, 3
  s_lshr_b32 s4, s37, 1
  s_and_b32 s5, s37, 1
  s_cmp_ge_u32 s2, 192
  s_cbranch_scc1 P1_REPACK
  s_and_b32 s6, s2, 7
  s_lshr_b32 s7, s2, 3
  s_and_b32 s31, s6, 3
  s_lshl_b32 s31, s31, 2
  s_and_b32 s32, s7, 3
  s_add_u32 s31, s31, s32
  s_lshr_b32 s32, s6, 2
  s_mul_i32 s32, s32, 6
  s_lshr_b32 s7, s7, 2
  s_add_u32 s32, s32, s7
  s_sub_u32 s34, s32, 4
  s_mov_b32 s52, 0x3fb8aa3b
  s_mov_b32 s53, 0x3fb8aa3b
  s_mov_b32 s54, 0xbfb8aa3b
  s_mov_b32 s55, 0xbfb8aa3b
  s_mov_b32 s56, 0x358637bd
  s_mov_b32 s57, 0x358637bd
  s_waitcnt lgkmcnt(0)
  s_mov_b32 s8, s40
  s_mov_b32 s9, s41
  s_mov_b32 s10, 0x200000
  s_mov_b32 s11, 0x20000
  s_mov_b32 s12, s42
  s_mov_b32 s13, s43
  s_mov_b32 s14, 0x180000
  s_mov_b32 s15, 0x20000
  s_mov_b32 s16, s50
  s_mov_b32 s17, s51
  s_mov_b32 s18, 0x200000
  s_mov_b32 s19, 0x20000
  s_add_u32 s20, s50, 0xd40000
  s_addc_u32 s21, s51, 0
  s_mov_b32 s22, 0x8800
  s_mov_b32 s23, 0x20000
  s_mov_b32 s24, s48
  s_mov_b32 s25, s49
  s_mov_b32 s26, 0x100
  s_mov_b32 s27, 0x20000
  s_cmp_ge_u32 s3, 4
  s_cbranch_scc1 P1_LOADER
  s_cmp_lt_u32 s32, 4
  s_cbranch_scc0 P1_KV
  v_and_b32 v2, 31, v1
  v_lshrrev_b32 v3, 5, v1
  v_lshrrev_b32 v4, 1, v2
  v_and_b32 v4, 7, v4
  v_xor_b32 v4, v4, v3
  v_lshlrev_b32 v5, 7, v2
  s_lshl_b32 s6, s4, 13
  s_add_u32 s6, s6, 4096
  v_add_u32 v5, s6, v5
  s_xor_b32 s6, s5, 0
  s_lshl_b32 s6, s6, 12
  v_xor_b32 v6, 0, v4
  v_lshl_add_u32 v6, v6, 4, v5
  v_add_u32 v144, s6, v6
  v_add_u32 v148, 0x10000, v144
  v_xor_b32 v6, 2, v4
  v_lshl_add_u32 v6, v6, 4, v5
  v_add_u32 v145, s6, v6
  v_add_u32 v149, 0x10000, v145
  v_xor_b32 v6, 4, v4
  v_lshl_add_u32 v6, v6, 4, v5
  v_add_u32 v146, s6, v6
  v_add_u32 v150, 0x10000, v146
  v_xor_b32 v6, 6, v4
  v_lshl_add_u32 v6, v6, 4, v5
  v_add_u32 v147, s6, v6
  v_add_u32 v151, 0x10000, v147
  s_xor_b32 s6, s5, 1
  s_lshl_b32 s6, s6, 12
  v_xor_b32 v6, 0, v4
  v_lshl_add_u32 v6, v6, 4, v5
  v_add_u32 v152, s6, v6
  v_add_u32 v156, 0x10000, v152
  v_xor_b32 v6, 2, v4
  v_lshl_add_u32 v6, v6, 4, v5
  v_add_u32 v153, s6, v6
  v_add_u32 v157, 0x10000, v153
  v_xor_b32 v6, 4, v4
  v_lshl_add_u32 v6, v6, 4, v5
  v_add_u32 v154, s6, v6
  v_add_u32 v158, 0x10000, v154
  v_xor_b32 v6, 6, v4
  v_lshl_add_u32 v6, v6, 4, v5
  v_add_u32 v155, s6, v6
  v_add_u32 v159, 0x10000, v155
  v_lshrrev_b32 v2, 4, v1
  v_and_b32 v3, 15, v1
  v_lshrrev_b32 v4, 5, v1
  v_lshlrev_b32 v4, 3, v4
  v_lshrrev_b32 v5, 2, v3
  v_add_u32 v4, v4, v5
  v_lshlrev_b32 v4, 8, v4
  v_and_b32 v6, 1, v2
  v_lshlrev_b32 v6, 1, v6
  v_bfe_u32 v7, v3, 1, 1
  v_add_u32 v6, v6, v7
  s_lshl_b32 s6, s5, 3
  v_add_u32 v6, s6, v6
  v_lshlrev_b32 v7, 2, v5
  v_and_b32 v8, 1, v3
  v_lshlrev_b32 v8, 3, v8
  v_add_u32 v4, 4096, v4
  s_xor_b32 s6, s4, 0
  s_lshl_b32 s6, s6, 2
  v_add_u32 v9, s6, v6
  v_xor_b32 v9, v9, v7
  v_lshlrev_b32 v9, 4, v9
  v_add3_u32 v160, v9, v4, v8
  v_add_u32 v162, 0x10000, v160
  s_xor_b32 s6, s4, 1
  s_lshl_b32 s6, s6, 2
  v_add_u32 v9, s6, v6
  v_xor_b32 v9, v9, v7
  v_lshlrev_b32 v9, 4, v9
  v_add3_u32 v161, v9, v4, v8
  v_add_u32 v163, 0x10000, v161
  v_and_b32 v2, 15, v1
  v_bfe_u32 v3, v1, 4, 1
  v_cmp_eq_u32 vcc, v2, v3
  v_mov_b32 v4, 0x3f803f80
  s_nop 0
  v_cndmask_b32 v24, 0, v4, vcc
  v_cndmask_b32 v25, 0, v4, vcc
  v_cndmask_b32 v26, 0, v4, vcc
  v_cndmask_b32 v27, 0, v4, vcc
  s_barrier
  ds_read_b128 v[96:99], v144 offset:0
  ds_read_b64_tr_b16 v[120:121], v160 offset:16384
  ds_read_b64_tr_b16 v[122:123], v160 offset:17408
  ds_read_b64_tr_b16 v[124:125], v161 offset:16384
  ds_read_b64_tr_b16 v[126:127], v161 offset:17408
  ds_read_b128 v[100:103], v152 offset:0
  ds_read_b128 v[104:107], v145 offset:0
  ds_read_b64_tr_b16 v[128:129], v160 offset:20480
  ds_read_b64_tr_b16 v[130:131], v160 offset:21504
  ds_read_b64_tr_b16 v[132:133], v161 offset:20480
  ds_read_b64_tr_b16 v[134:135], v161 offset:21504
  ds_read_b128 v[108:111], v153 offset:0
  s_waitcnt lgkmcnt(6)
  v_mfma_f32_32x32x16_bf16 v[32:47], v[120:123], v[96:99], 0
  ds_read_b128 v[112:115], v146 offset:0
  ds_read_b64_tr_b16 v[136:137], v160 offset:24576
  v_mfma_f32_32x32x16_bf16 v[164:179], v[96:99], v[96:99], 0
  v_mfma_f32_32x32x16_bf16 v[48:63], v[124:127], v[96:99], 0
  ds_read_b64_tr_b16 v[138:139], v160 offset:25600
  ds_read_b64_tr_b16 v[140:141], v161 offset:24576
  v_mfma_f32_16x16x32_bf16 v[180:183], v[24:27], v[96:99], 0
  v_mfma_f32_32x32x16_bf16 v[64:79], v[120:123], v[100:103], 0
  ds_read_b64_tr_b16 v[142:143], v161 offset:25600
  ds_read_b128 v[116:119], v154 offset:0
  v_mfma_f32_16x16x32_bf16 v[184:187], v[24:27], v[120:123], 0
  v_mfma_f32_32x32x16_bf16 v[80:95], v[124:127], v[100:103], 0
  s_waitcnt lgkmcnt(6)
  v_mfma_f32_32x32x16_bf16 v[32:47], v[128:131], v[104:107], v[32:47]
  ds_read_b128 v[96:99], v147 offset:0
  ds_read_b64_tr_b16 v[120:121], v160 offset:28672
  v_mfma_f32_32x32x16_bf16 v[164:179], v[104:107], v[104:107], v[164:179]
  v_mfma_f32_32x32x16_bf16 v[48:63], v[132:135], v[104:107], v[48:63]
  ds_read_b64_tr_b16 v[122:123], v160 offset:29696
  ds_read_b64_tr_b16 v[124:125], v161 offset:28672
  v_mfma_f32_16x16x32_bf16 v[180:183], v[24:27], v[104:107], v[180:183]
  v_mfma_f32_32x32x16_bf16 v[64:79], v[128:131], v[108:111], v[64:79]
  ds_read_b64_tr_b16 v[126:127], v161 offset:29696
  ds_read_b128 v[100:103], v155 offset:0
  v_mfma_f32_16x16x32_bf16 v[184:187], v[24:27], v[128:131], v[184:187]
  v_mfma_f32_32x32x16_bf16 v[80:95], v[132:135], v[108:111], v[80:95]
  s_waitcnt lgkmcnt(0)
  s_barrier
  v_mfma_f32_32x32x16_bf16 v[32:47], v[136:139], v[112:115], v[32:47]
  ds_read_b128 v[104:107], v144 offset:32768
  ds_read_b64_tr_b16 v[128:129], v160 offset:49152
  v_mfma_f32_32x32x16_bf16 v[164:179], v[112:115], v[112:115], v[164:179]
  v_mfma_f32_32x32x16_bf16 v[48:63], v[140:143], v[112:115], v[48:63]
  ds_read_b64_tr_b16 v[130:131], v160 offset:50176
  ds_read_b64_tr_b16 v[132:133], v161 offset:49152
  v_mfma_f32_16x16x32_bf16 v[180:183], v[24:27], v[112:115], v[180:183]
  v_mfma_f32_32x32x16_bf16 v[64:79], v[136:139], v[116:119], v[64:79]
  ds_read_b64_tr_b16 v[134:135], v161 offset:50176
  ds_read_b128 v[108:111], v152 offset:32768
  v_mfma_f32_16x16x32_bf16 v[184:187], v[24:27], v[136:139], v[184:187]
  v_mfma_f32_32x32x16_bf16 v[80:95], v[140:143], v[116:119], v[80:95]
  s_waitcnt lgkmcnt(6)
  v_mfma_f32_32x32x16_bf16 v[32:47], v[120:123], v[96:99], v[32:47]
  ds_read_b128 v[112:115], v145 offset:32768
  ds_read_b64_tr_b16 v[136:137], v160 offset:53248
  v_mfma_f32_32x32x16_bf16 v[164:179], v[96:99], v[96:99], v[164:179]
  v_mfma_f32_32x32x16_bf16 v[48:63], v[124:127], v[96:99], v[48:63]
  ds_read_b64_tr_b16 v[138:139], v160 offset:54272
  ds_read_b64_tr_b16 v[140:141], v161 offset:53248
  v_mfma_f32_16x16x32_bf16 v[180:183], v[24:27], v[96:99], v[180:183]
  v_mfma_f32_32x32x16_bf16 v[64:79], v[120:123], v[100:103], v[64:79]
  ds_read_b64_tr_b16 v[142:143], v161 offset:54272
  ds_read_b128 v[116:119], v153 offset:32768
  v_mfma_f32_16x16x32_bf16 v[184:187], v[24:27], v[120:123], v[184:187]
  v_mfma_f32_32x32x16_bf16 v[80:95], v[124:127], v[100:103], v[80:95]
  s_waitcnt lgkmcnt(6)
  v_mfma_f32_32x32x16_bf16 v[32:47], v[128:131], v[104:107], v[32:47]
  ds_read_b128 v[96:99], v146 offset:32768
  ds_read_b64_tr_b16 v[120:121], v160 offset:57344
  v_mfma_f32_32x32x16_bf16 v[164:179], v[104:107], v[104:107], v[164:179]
  v_mfma_f32_32x32x16_bf16 v[48:63], v[132:135], v[104:107], v[48:63]
  ds_read_b64_tr_b16 v[122:123], v160 offset:58368
  ds_read_b64_tr_b16 v[124:125], v161 offset:57344
  v_mfma_f32_16x16x32_bf16 v[180:183], v[24:27], v[104:107], v[180:183]
  v_mfma_f32_32x32x16_bf16 v[64:79], v[128:131], v[108:111], v[64:79]
  ds_read_b64_tr_b16 v[126:127], v161 offset:58368
  ds_read_b128 v[100:103], v154 offset:32768
  v_mfma_f32_16x16x32_bf16 v[184:187], v[24:27], v[128:131], v[184:187]
  v_mfma_f32_32x32x16_bf16 v[80:95], v[132:135], v[108:111], v[80:95]
  s_waitcnt lgkmcnt(6)
  v_mfma_f32_32x32x16_bf16 v[32:47], v[136:139], v[112:115], v[32:47]
  ds_read_b128 v[104:107], v147 offset:32768
  ds_read_b64_tr_b16 v[128:129], v160 offset:61440
  v_mfma_f32_32x32x16_bf16 v[164:179], v[112:115], v[112:115], v[164:179]
  v_mfma_f32_32x32x16_bf16 v[48:63], v[140:143], v[112:115], v[48:63]
  ds_read_b64_tr_b16 v[130:131], v160 offset:62464
  ds_read_b64_tr_b16 v[132:133], v161 offset:61440
  v_mfma_f32_16x16x32_bf16 v[180:183], v[24:27], v[112:115], v[180:183]
  v_mfma_f32_32x32x16_bf16 v[64:79], v[136:139], v[116:119], v[64:79]
  ds_read_b64_tr_b16 v[134:135], v161 offset:62464
  ds_read_b128 v[108:111], v155 offset:32768
  v_mfma_f32_16x16x32_bf16 v[184:187], v[24:27], v[136:139], v[184:187]
  v_mfma_f32_32x32x16_bf16 v[80:95], v[140:143], v[116:119], v[80:95]
  s_waitcnt lgkmcnt(0)
  s_barrier
  v_mfma_f32_32x32x16_bf16 v[32:47], v[120:123], v[96:99], v[32:47]
  ds_read_b128 v[112:115], v148 offset:0
  ds_read_b64_tr_b16 v[136:137], v162 offset:16384
  v_mfma_f32_32x32x16_bf16 v[164:179], v[96:99], v[96:99], v[164:179]
  v_mfma_f32_32x32x16_bf16 v[48:63], v[124:127], v[96:99], v[48:63]
  ds_read_b64_tr_b16 v[138:139], v162 offset:17408
  ds_read_b64_tr_b16 v[140:141], v163 offset:16384
  v_mfma_f32_16x16x32_bf16 v[180:183], v[24:27], v[96:99], v[180:183]
  v_mfma_f32_32x32x16_bf16 v[64:79], v[120:123], v[100:103], v[64:79]
  ds_read_b64_tr_b16 v[142:143], v163 offset:17408
  ds_read_b128 v[116:119], v156 offset:0
  v_mfma_f32_16x16x32_bf16 v[184:187], v[24:27], v[120:123], v[184:187]
  v_mfma_f32_32x32x16_bf16 v[80:95], v[124:127], v[100:103], v[80:95]
  s_waitcnt lgkmcnt(6)
  v_mfma_f32_32x32x16_bf16 v[32:47], v[128:131], v[104:107], v[32:47]
  ds_read_b128 v[96:99], v149 offset:0
  ds_read_b64_tr_b16 v[120:121], v162 offset:20480
  v_mfma_f32_32x32x16_bf16 v[164:179], v[104:107], v[104:107], v[164:179]
  v_mfma_f32_32x32x16_bf16 v[48:63], v[132:135], v[104:107], v[48:63]
  ds_read_b64_tr_b16 v[122:123], v162 offset:21504
  ds_read_b64_tr_b16 v[124:125], v163 offset:20480
  v_mfma_f32_16x16x32_bf16 v[180:183], v[24:27], v[104:107], v[180:183]
  v_mfma_f32_32x32x16_bf16 v[64:79], v[128:131], v[108:111], v[64:79]
  ds_read_b64_tr_b16 v[126:127], v163 offset:21504
  ds_read_b128 v[100:103], v157 offset:0
  v_mfma_f32_16x16x32_bf16 v[184:187], v[24:27], v[128:131], v[184:187]
  v_mfma_f32_32x32x16_bf16 v[80:95], v[132:135], v[108:111], v[80:95]
  s_waitcnt lgkmcnt(6)
  v_mfma_f32_32x32x16_bf16 v[32:47], v[136:139], v[112:115], v[32:47]
  ds_read_b128 v[104:107], v150 offset:0
  ds_read_b64_tr_b16 v[128:129], v162 offset:24576
  v_mfma_f32_32x32x16_bf16 v[164:179], v[112:115], v[112:115], v[164:179]
  v_mfma_f32_32x32x16_bf16 v[48:63], v[140:143], v[112:115], v[48:63]
  ds_read_b64_tr_b16 v[130:131], v162 offset:25600
  ds_read_b64_tr_b16 v[132:133], v163 offset:24576
  v_mfma_f32_16x16x32_bf16 v[180:183], v[24:27], v[112:115], v[180:183]
  v_mfma_f32_32x32x16_bf16 v[64:79], v[136:139], v[116:119], v[64:79]
  ds_read_b64_tr_b16 v[134:135], v163 offset:25600
  ds_read_b128 v[108:111], v158 offset:0
  v_mfma_f32_16x16x32_bf16 v[184:187], v[24:27], v[136:139], v[184:187]
  v_mfma_f32_32x32x16_bf16 v[80:95], v[140:143], v[116:119], v[80:95]
  s_waitcnt lgkmcnt(6)
  v_mfma_f32_32x32x16_bf16 v[32:47], v[120:123], v[96:99], v[32:47]
  ds_read_b128 v[112:115], v151 offset:0
  ds_read_b64_tr_b16 v[136:137], v162 offset:28672
  v_mfma_f32_32x32x16_bf16 v[164:179], v[96:99], v[96:99], v[164:179]
  v_mfma_f32_32x32x16_bf16 v[48:63], v[124:127], v[96:99], v[48:63]
  ds_read_b64_tr_b16 v[138:139], v162 offset:29696
  ds_read_b64_tr_b16 v[140:141], v163 offset:28672
  v_mfma_f32_16x16x32_bf16 v[180:183], v[24:27], v[96:99], v[180:183]
  v_mfma_f32_32x32x16_bf16 v[64:79], v[120:123], v[100:103], v[64:79]
  ds_read_b64_tr_b16 v[142:143], v163 offset:29696
  ds_read_b128 v[116:119], v159 offset:0
  v_mfma_f32_16x16x32_bf16 v[184:187], v[24:27], v[120:123], v[184:187]
  v_mfma_f32_32x32x16_bf16 v[80:95], v[124:127], v[100:103], v[80:95]
  s_waitcnt lgkmcnt(0)
  s_barrier
  v_mfma_f32_32x32x16_bf16 v[32:47], v[128:131], v[104:107], v[32:47]
  ds_read_b128 v[96:99], v148 offset:32768
  ds_read_b64_tr_b16 v[120:121], v162 offset:49152
  v_mfma_f32_32x32x16_bf16 v[164:179], v[104:107], v[104:107], v[164:179]
  v_mfma_f32_32x32x16_bf16 v[48:63], v[132:135], v[104:107], v[48:63]
  ds_read_b64_tr_b16 v[122:123], v162 offset:50176
  ds_read_b64_tr_b16 v[124:125], v163 offset:49152
  v_mfma_f32_16x16x32_bf16 v[180:183], v[24:27], v[104:107], v[180:183]
  v_mfma_f32_32x32x16_bf16 v[64:79], v[128:131], v[108:111], v[64:79]
  ds_read_b64_tr_b16 v[126:127], v163 offset:50176
  ds_read_b128 v[100:103], v156 offset:32768
  v_mfma_f32_16x16x32_bf16 v[184:187], v[24:27], v[128:131], v[184:187]
  v_mfma_f32_32x32x16_bf16 v[80:95], v[132:135], v[108:111], v[80:95]
  s_waitcnt lgkmcnt(6)
  v_mfma_f32_32x32x16_bf16 v[32:47], v[136:139], v[112:115], v[32:47]
  ds_read_b128 v[104:107], v149 offset:32768
  ds_read_b64_tr_b16 v[128:129], v162 offset:53248
  v_mfma_f32_32x32x16_bf16 v[164:179], v[112:115], v[112:115], v[164:179]
  v_mfma_f32_32x32x16_bf16 v[48:63], v[140:143], v[112:115], v[48:63]
  ds_read_b64_tr_b16 v[130:131], v162 offset:54272
  ds_read_b64_tr_b16 v[132:133], v163 offset:53248
  v_mfma_f32_16x16x32_bf16 v[180:183], v[24:27], v[112:115], v[180:183]
  v_mfma_f32_32x32x16_bf16 v[64:79], v[136:139], v[116:119], v[64:79]
  ds_read_b64_tr_b16 v[134:135], v163 offset:54272
  ds_read_b128 v[108:111], v157 offset:32768
  v_mfma_f32_16x16x32_bf16 v[184:187], v[24:27], v[136:139], v[184:187]
  v_mfma_f32_32x32x16_bf16 v[80:95], v[140:143], v[116:119], v[80:95]
  s_waitcnt lgkmcnt(6)
  v_mfma_f32_32x32x16_bf16 v[32:47], v[120:123], v[96:99], v[32:47]
  ds_read_b128 v[112:115], v150 offset:32768
  ds_read_b64_tr_b16 v[136:137], v162 offset:57344
  v_mfma_f32_32x32x16_bf16 v[164:179], v[96:99], v[96:99], v[164:179]
  v_mfma_f32_32x32x16_bf16 v[48:63], v[124:127], v[96:99], v[48:63]
  ds_read_b64_tr_b16 v[138:139], v162 offset:58368
  ds_read_b64_tr_b16 v[140:141], v163 offset:57344
  v_mfma_f32_16x16x32_bf16 v[180:183], v[24:27], v[96:99], v[180:183]
  v_mfma_f32_32x32x16_bf16 v[64:79], v[120:123], v[100:103], v[64:79]
  ds_read_b64_tr_b16 v[142:143], v163 offset:58368
  ds_read_b128 v[116:119], v158 offset:32768
  v_mfma_f32_16x16x32_bf16 v[184:187], v[24:27], v[120:123], v[184:187]
  v_mfma_f32_32x32x16_bf16 v[80:95], v[124:127], v[100:103], v[80:95]
  s_waitcnt lgkmcnt(6)
  v_mfma_f32_32x32x16_bf16 v[32:47], v[128:131], v[104:107], v[32:47]
  ds_read_b128 v[96:99], v151 offset:32768
  ds_read_b64_tr_b16 v[120:121], v162 offset:61440
  v_mfma_f32_32x32x16_bf16 v[164:179], v[104:107], v[104:107], v[164:179]
  v_mfma_f32_32x32x16_bf16 v[48:63], v[132:135], v[104:107], v[48:63]
  ds_read_b64_tr_b16 v[122:123], v162 offset:62464
  ds_read_b64_tr_b16 v[124:125], v163 offset:61440
  v_mfma_f32_16x16x32_bf16 v[180:183], v[24:27], v[104:107], v[180:183]
  v_mfma_f32_32x32x16_bf16 v[64:79], v[128:131], v[108:111], v[64:79]
  ds_read_b64_tr_b16 v[126:127], v163 offset:62464
  ds_read_b128 v[100:103], v159 offset:32768
  v_mfma_f32_16x16x32_bf16 v[184:187], v[24:27], v[128:131], v[184:187]
  v_mfma_f32_32x32x16_bf16 v[80:95], v[132:135], v[108:111], v[80:95]
  s_waitcnt lgkmcnt(0)
  s_barrier
  v_mfma_f32_32x32x16_bf16 v[32:47], v[136:139], v[112:115], v[32:47]
  ds_read_b128 v[104:107], v144 offset:0
  ds_read_b64_tr_b16 v[128:129], v160 offset:16384
  v_mfma_f32_32x32x16_bf16 v[164:179], v[112:115], v[112:115], v[164:179]
  v_mfma_f32_32x32x16_bf16 v[48:63], v[140:143], v[112:115], v[48:63]
  ds_read_b64_tr_b16 v[130:131], v160 offset:17408
  ds_read_b64_tr_b16 v[132:133], v161 offset:16384
  v_mfma_f32_16x16x32_bf16 v[180:183], v[24:27], v[112:115], v[180:183]
  v_mfma_f32_32x32x16_bf16 v[64:79], v[136:139], v[116:119], v[64:79]
  ds_read_b64_tr_b16 v[134:135], v161 offset:17408
  ds_read_b128 v[108:111], v152 offset:0
  v_mfma_f32_16x16x32_bf16 v[184:187], v[24:27], v[136:139], v[184:187]
  v_mfma_f32_32x32x16_bf16 v[80:95], v[140:143], v[116:119], v[80:95]
  s_waitcnt lgkmcnt(6)
  v_mfma_f32_32x32x16_bf16 v[32:47], v[120:123], v[96:99], v[32:47]
  ds_read_b128 v[112:115], v145 offset:0
  ds_read_b64_tr_b16 v[136:137], v160 offset:20480
  v_mfma_f32_32x32x16_bf16 v[164:179], v[96:99], v[96:99], v[164:179]
  v_mfma_f32_32x32x16_bf16 v[48:63], v[124:127], v[96:99], v[48:63]
  ds_read_b64_tr_b16 v[138:139], v160 offset:21504
  ds_read_b64_tr_b16 v[140:141], v161 offset:20480
  v_mfma_f32_16x16x32_bf16 v[180:183], v[24:27], v[96:99], v[180:183]
  v_mfma_f32_32x32x16_bf16 v[64:79], v[120:123], v[100:103], v[64:79]
  ds_read_b64_tr_b16 v[142:143], v161 offset:21504
  ds_read_b128 v[116:119], v153 offset:0
  v_mfma_f32_16x16x32_bf16 v[184:187], v[24:27], v[120:123], v[184:187]
  v_mfma_f32_32x32x16_bf16 v[80:95], v[124:127], v[100:103], v[80:95]
  s_waitcnt lgkmcnt(6)
  v_mfma_f32_32x32x16_bf16 v[32:47], v[128:131], v[104:107], v[32:47]
  ds_read_b128 v[96:99], v146 offset:0
  ds_read_b64_tr_b16 v[120:121], v160 offset:24576
  v_mfma_f32_32x32x16_bf16 v[164:179], v[104:107], v[104:107], v[164:179]
  v_mfma_f32_32x32x16_bf16 v[48:63], v[132:135], v[104:107], v[48:63]
  ds_read_b64_tr_b16 v[122:123], v160 offset:25600
  ds_read_b64_tr_b16 v[124:125], v161 offset:24576
  v_mfma_f32_16x16x32_bf16 v[180:183], v[24:27], v[104:107], v[180:183]
  v_mfma_f32_32x32x16_bf16 v[64:79], v[128:131], v[108:111], v[64:79]
  ds_read_b64_tr_b16 v[126:127], v161 offset:25600
  ds_read_b128 v[100:103], v154 offset:0
  v_mfma_f32_16x16x32_bf16 v[184:187], v[24:27], v[128:131], v[184:187]
  v_mfma_f32_32x32x16_bf16 v[80:95], v[132:135], v[108:111], v[80:95]
  s_waitcnt lgkmcnt(6)
  v_mfma_f32_32x32x16_bf16 v[32:47], v[136:139], v[112:115], v[32:47]
  ds_read_b128 v[104:107], v147 offset:0
  ds_read_b64_tr_b16 v[128:129], v160 offset:28672
  v_mfma_f32_32x32x16_bf16 v[164:179], v[112:115], v[112:115], v[164:179]
  v_mfma_f32_32x32x16_bf16 v[48:63], v[140:143], v[112:115], v[48:63]
  ds_read_b64_tr_b16 v[130:131], v160 offset:29696
  ds_read_b64_tr_b16 v[132:133], v161 offset:28672
  v_mfma_f32_16x16x32_bf16 v[180:183], v[24:27], v[112:115], v[180:183]
  v_mfma_f32_32x32x16_bf16 v[64:79], v[136:139], v[116:119], v[64:79]
  ds_read_b64_tr_b16 v[134:135], v161 offset:29696
  ds_read_b128 v[108:111], v155 offset:0
  v_mfma_f32_16x16x32_bf16 v[184:187], v[24:27], v[136:139], v[184:187]
  v_mfma_f32_32x32x16_bf16 v[80:95], v[140:143], v[116:119], v[80:95]
  s_waitcnt lgkmcnt(0)
  s_barrier
  v_mfma_f32_32x32x16_bf16 v[32:47], v[120:123], v[96:99], v[32:47]
  ds_read_b128 v[112:115], v144 offset:32768
  ds_read_b64_tr_b16 v[136:137], v160 offset:49152
  v_mfma_f32_32x32x16_bf16 v[164:179], v[96:99], v[96:99], v[164:179]
  v_mfma_f32_32x32x16_bf16 v[48:63], v[124:127], v[96:99], v[48:63]
  ds_read_b64_tr_b16 v[138:139], v160 offset:50176
  ds_read_b64_tr_b16 v[140:141], v161 offset:49152
  v_mfma_f32_16x16x32_bf16 v[180:183], v[24:27], v[96:99], v[180:183]
  v_mfma_f32_32x32x16_bf16 v[64:79], v[120:123], v[100:103], v[64:79]
  ds_read_b64_tr_b16 v[142:143], v161 offset:50176
  ds_read_b128 v[116:119], v152 offset:32768
  v_mfma_f32_16x16x32_bf16 v[184:187], v[24:27], v[120:123], v[184:187]
  v_mfma_f32_32x32x16_bf16 v[80:95], v[124:127], v[100:103], v[80:95]
  s_waitcnt lgkmcnt(6)
  v_mfma_f32_32x32x16_bf16 v[32:47], v[128:131], v[104:107], v[32:47]
  ds_read_b128 v[96:99], v145 offset:32768
  ds_read_b64_tr_b16 v[120:121], v160 offset:53248
  v_mfma_f32_32x32x16_bf16 v[164:179], v[104:107], v[104:107], v[164:179]
  v_mfma_f32_32x32x16_bf16 v[48:63], v[132:135], v[104:107], v[48:63]
  ds_read_b64_tr_b16 v[122:123], v160 offset:54272
  ds_read_b64_tr_b16 v[124:125], v161 offset:53248
  v_mfma_f32_16x16x32_bf16 v[180:183], v[24:27], v[104:107], v[180:183]
  v_mfma_f32_32x32x16_bf16 v[64:79], v[128:131], v[108:111], v[64:79]
  ds_read_b64_tr_b16 v[126:127], v161 offset:54272
  ds_read_b128 v[100:103], v153 offset:32768
  v_mfma_f32_16x16x32_bf16 v[184:187], v[24:27], v[128:131], v[184:187]
  v_mfma_f32_32x32x16_bf16 v[80:95], v[132:135], v[108:111], v[80:95]
  s_waitcnt lgkmcnt(6)
  v_mfma_f32_32x32x16_bf16 v[32:47], v[136:139], v[112:115], v[32:47]
  ds_read_b128 v[104:107], v146 offset:32768
  ds_read_b64_tr_b16 v[128:129], v160 offset:57344
  v_mfma_f32_32x32x16_bf16 v[164:179], v[112:115], v[112:115], v[164:179]
  v_mfma_f32_32x32x16_bf16 v[48:63], v[140:143], v[112:115], v[48:63]
  ds_read_b64_tr_b16 v[130:131], v160 offset:58368
  ds_read_b64_tr_b16 v[132:133], v161 offset:57344
  v_mfma_f32_16x16x32_bf16 v[180:183], v[24:27], v[112:115], v[180:183]
  v_mfma_f32_32x32x16_bf16 v[64:79], v[136:139], v[116:119], v[64:79]
  ds_read_b64_tr_b16 v[134:135], v161 offset:58368
  ds_read_b128 v[108:111], v154 offset:32768
  v_mfma_f32_16x16x32_bf16 v[184:187], v[24:27], v[136:139], v[184:187]
  v_mfma_f32_32x32x16_bf16 v[80:95], v[140:143], v[116:119], v[80:95]
  s_waitcnt lgkmcnt(6)
  v_mfma_f32_32x32x16_bf16 v[32:47], v[120:123], v[96:99], v[32:47]
  ds_read_b128 v[112:115], v147 offset:32768
  ds_read_b64_tr_b16 v[136:137], v160 offset:61440
  v_mfma_f32_32x32x16_bf16 v[164:179], v[96:99], v[96:99], v[164:179]
  v_mfma_f32_32x32x16_bf16 v[48:63], v[124:127], v[96:99], v[48:63]
  ds_read_b64_tr_b16 v[138:139], v160 offset:62464
  ds_read_b64_tr_b16 v[140:141], v161 offset:61440
  v_mfma_f32_16x16x32_bf16 v[180:183], v[24:27], v[96:99], v[180:183]
  v_mfma_f32_32x32x16_bf16 v[64:79], v[120:123], v[100:103], v[64:79]
  ds_read_b64_tr_b16 v[142:143], v161 offset:62464
  ds_read_b128 v[116:119], v155 offset:32768
  v_mfma_f32_16x16x32_bf16 v[184:187], v[24:27], v[120:123], v[184:187]
  v_mfma_f32_32x32x16_bf16 v[80:95], v[124:127], v[100:103], v[80:95]
  s_waitcnt lgkmcnt(0)
  s_barrier
  v_mfma_f32_32x32x16_bf16 v[32:47], v[128:131], v[104:107], v[32:47]
  ds_read_b128 v[96:99], v148 offset:0
  ds_read_b64_tr_b16 v[120:121], v162 offset:16384
  v_mfma_f32_32x32x16_bf16 v[164:179], v[104:107], v[104:107], v[164:179]
  v_mfma_f32_32x32x16_bf16 v[48:63], v[132:135], v[104:107], v[48:63]
  ds_read_b64_tr_b16 v[122:123], v162 offset:17408
  ds_read_b64_tr_b16 v[124:125], v163 offset:16384
  v_mfma_f32_16x16x32_bf16 v[180:183], v[24:27], v[104:107], v[180:183]
  v_mfma_f32_32x32x16_bf16 v[64:79], v[128:131], v[108:111], v[64:79]
  ds_read_b64_tr_b16 v[126:127], v163 offset:17408
  ds_read_b128 v[100:103], v156 offset:0
  v_mfma_f32_16x16x32_bf16 v[184:187], v[24:27], v[128:131], v[184:187]
  v_mfma_f32_32x32x16_bf16 v[80:95], v[132:135], v[108:111], v[80:95]
  s_waitcnt lgkmcnt(6)
  v_mfma_f32_32x32x16_bf16 v[32:47], v[136:139], v[112:115], v[32:47]
  ds_read_b128 v[104:107], v149 offset:0
  ds_read_b64_tr_b16 v[128:129], v162 offset:20480
  v_mfma_f32_32x32x16_bf16 v[164:179], v[112:115], v[112:115], v[164:179]
  v_mfma_f32_32x32x16_bf16 v[48:63], v[140:143], v[112:115], v[48:63]
  ds_read_b64_tr_b16 v[130:131], v162 offset:21504
  ds_read_b64_tr_b16 v[132:133], v163 offset:20480
  v_mfma_f32_16x16x32_bf16 v[180:183], v[24:27], v[112:115], v[180:183]
  v_mfma_f32_32x32x16_bf16 v[64:79], v[136:139], v[116:119], v[64:79]
  ds_read_b64_tr_b16 v[134:135], v163 offset:21504
  ds_read_b128 v[108:111], v157 offset:0
  v_mfma_f32_16x16x32_bf16 v[184:187], v[24:27], v[136:139], v[184:187]
  v_mfma_f32_32x32x16_bf16 v[80:95], v[140:143], v[116:119], v[80:95]
  s_waitcnt lgkmcnt(6)
  v_mfma_f32_32x32x16_bf16 v[32:47], v[120:123], v[96:99], v[32:47]
  ds_read_b128 v[112:115], v150 offset:0
  ds_read_b64_tr_b16 v[136:137], v162 offset:24576
  v_mfma_f32_32x32x16_bf16 v[164:179], v[96:99], v[96:99], v[164:179]
  v_mfma_f32_32x32x16_bf16 v[48:63], v[124:127], v[96:99], v[48:63]
  ds_read_b64_tr_b16 v[138:139], v162 offset:25600
  ds_read_b64_tr_b16 v[140:141], v163 offset:24576
  v_mfma_f32_16x16x32_bf16 v[180:183], v[24:27], v[96:99], v[180:183]
  v_mfma_f32_32x32x16_bf16 v[64:79], v[120:123], v[100:103], v[64:79]
  ds_read_b64_tr_b16 v[142:143], v163 offset:25600
  ds_read_b128 v[116:119], v158 offset:0
  v_mfma_f32_16x16x32_bf16 v[184:187], v[24:27], v[120:123], v[184:187]
  v_mfma_f32_32x32x16_bf16 v[80:95], v[124:127], v[100:103], v[80:95]
  s_waitcnt lgkmcnt(6)
  v_mfma_f32_32x32x16_bf16 v[32:47], v[128:131], v[104:107], v[32:47]
  ds_read_b128 v[96:99], v151 offset:0
  ds_read_b64_tr_b16 v[120:121], v162 offset:28672
  v_mfma_f32_32x32x16_bf16 v[164:179], v[104:107], v[104:107], v[164:179]
  v_mfma_f32_32x32x16_bf16 v[48:63], v[132:135], v[104:107], v[48:63]
  ds_read_b64_tr_b16 v[122:123], v162 offset:29696
  ds_read_b64_tr_b16 v[124:125], v163 offset:28672
  v_mfma_f32_16x16x32_bf16 v[180:183], v[24:27], v[104:107], v[180:183]
  v_mfma_f32_32x32x16_bf16 v[64:79], v[128:131], v[108:111], v[64:79]
  ds_read_b64_tr_b16 v[126:127], v163 offset:29696
  ds_read_b128 v[100:103], v159 offset:0
  v_mfma_f32_16x16x32_bf16 v[184:187], v[24:27], v[128:131], v[184:187]
  v_mfma_f32_32x32x16_bf16 v[80:95], v[132:135], v[108:111], v[80:95]
  s_waitcnt lgkmcnt(0)
  s_barrier
  v_mfma_f32_32x32x16_bf16 v[32:47], v[136:139], v[112:115], v[32:47]
  ds_read_b128 v[104:107], v148 offset:32768
  ds_read_b64_tr_b16 v[128:129], v162 offset:49152
  v_mfma_f32_32x32x16_bf16 v[164:179], v[112:115], v[112:115], v[164:179]
  v_mfma_f32_32x32x16_bf16 v[48:63], v[140:143], v[112:115], v[48:63]
  ds_read_b64_tr_b16 v[130:131], v162 offset:50176
  ds_read_b64_tr_b16 v[132:133], v163 offset:49152
  v_mfma_f32_16x16x32_bf16 v[180:183], v[24:27], v[112:115], v[180:183]
  v_mfma_f32_32x32x16_bf16 v[64:79], v[136:139], v[116:119], v[64:79]
  ds_read_b64_tr_b16 v[134:135], v163 offset:50176
  ds_read_b128 v[108:111], v156 offset:32768
  v_mfma_f32_16x16x32_bf16 v[184:187], v[24:27], v[136:139], v[184:187]
  v_mfma_f32_32x32x16_bf16 v[80:95], v[140:143], v[116:119], v[80:95]
  s_waitcnt lgkmcnt(6)
  v_mfma_f32_32x32x16_bf16 v[32:47], v[120:123], v[96:99], v[32:47]
  ds_read_b128 v[112:115], v149 offset:32768
  ds_read_b64_tr_b16 v[136:137], v162 offset:53248
  v_mfma_f32_32x32x16_bf16 v[164:179], v[96:99], v[96:99], v[164:179]
  v_mfma_f32_32x32x16_bf16 v[48:63], v[124:127], v[96:99], v[48:63]
  ds_read_b64_tr_b16 v[138:139], v162 offset:54272
  ds_read_b64_tr_b16 v[140:141], v163 offset:53248
  v_mfma_f32_16x16x32_bf16 v[180:183], v[24:27], v[96:99], v[180:183]
  v_mfma_f32_32x32x16_bf16 v[64:79], v[120:123], v[100:103], v[64:79]
  ds_read_b64_tr_b16 v[142:143], v163 offset:54272
  ds_read_b128 v[116:119], v157 offset:32768
  v_mfma_f32_16x16x32_bf16 v[184:187], v[24:27], v[120:123], v[184:187]
  v_mfma_f32_32x32x16_bf16 v[80:95], v[124:127], v[100:103], v[80:95]
  s_waitcnt lgkmcnt(6)
  v_mfma_f32_32x32x16_bf16 v[32:47], v[128:131], v[104:107], v[32:47]
  ds_read_b128 v[96:99], v150 offset:32768
  ds_read_b64_tr_b16 v[120:121], v162 offset:57344
  v_mfma_f32_32x32x16_bf16 v[164:179], v[104:107], v[104:107], v[164:179]
  v_mfma_f32_32x32x16_bf16 v[48:63], v[132:135], v[104:107], v[48:63]
  ds_read_b64_tr_b16 v[122:123], v162 offset:58368
  ds_read_b64_tr_b16 v[124:125], v163 offset:57344
  v_mfma_f32_16x16x32_bf16 v[180:183], v[24:27], v[104:107], v[180:183]
  v_mfma_f32_32x32x16_bf16 v[64:79], v[128:131], v[108:111], v[64:79]
  ds_read_b64_tr_b16 v[126:127], v163 offset:58368
  ds_read_b128 v[100:103], v158 offset:32768
  v_mfma_f32_16x16x32_bf16 v[184:187], v[24:27], v[128:131], v[184:187]
  v_mfma_f32_32x32x16_bf16 v[80:95], v[132:135], v[108:111], v[80:95]
  s_waitcnt lgkmcnt(6)
  v_mfma_f32_32x32x16_bf16 v[32:47], v[136:139], v[112:115], v[32:47]
  ds_read_b128 v[104:107], v151 offset:32768
  ds_read_b64_tr_b16 v[128:129], v162 offset:61440
  v_mfma_f32_32x32x16_bf16 v[164:179], v[112:115], v[112:115], v[164:179]
  v_mfma_f32_32x32x16_bf16 v[48:63], v[140:143], v[112:115], v[48:63]
  ds_read_b64_tr_b16 v[130:131], v162 offset:62464
  ds_read_b64_tr_b16 v[132:133], v163 offset:61440
  v_mfma_f32_16x16x32_bf16 v[180:183], v[24:27], v[112:115], v[180:183]
  v_mfma_f32_32x32x16_bf16 v[64:79], v[136:139], v[116:119], v[64:79]
  ds_read_b64_tr_b16 v[134:135], v163 offset:62464
  ds_read_b128 v[108:111], v159 offset:32768
  v_mfma_f32_16x16x32_bf16 v[184:187], v[24:27], v[136:139], v[184:187]
  v_mfma_f32_32x32x16_bf16 v[80:95], v[140:143], v[116:119], v[80:95]
  s_waitcnt lgkmcnt(6)
  v_mfma_f32_32x32x16_bf16 v[32:47], v[120:123], v[96:99], v[32:47]
  v_mfma_f32_32x32x16_bf16 v[164:179], v[96:99], v[96:99], v[164:179]
  v_mfma_f32_32x32x16_bf16 v[48:63], v[124:127], v[96:99], v[48:63]
  v_mfma_f32_16x16x32_bf16 v[180:183], v[24:27], v[96:99], v[180:183]
  v_mfma_f32_32x32x16_bf16 v[64:79], v[120:123], v[100:103], v[64:79]
  v_mfma_f32_16x16x32_bf16 v[184:187], v[24:27], v[120:123], v[184:187]
  v_mfma_f32_32x32x16_bf16 v[80:95], v[124:127], v[100:103], v[80:95]
  s_waitcnt lgkmcnt(0)
  v_mfma_f32_32x32x16_bf16 v[32:47], v[128:131], v[104:107], v[32:47]
  v_mfma_f32_32x32x16_bf16 v[164:179], v[104:107], v[104:107], v[164:179]
  v_mfma_f32_32x32x16_bf16 v[48:63], v[132:135], v[104:107], v[48:63]
  v_mfma_f32_16x16x32_bf16 v[180:183], v[24:27], v[104:107], v[180:183]
  v_mfma_f32_32x32x16_bf16 v[64:79], v[128:131], v[108:111], v[64:79]
  v_mfma_f32_16x16x32_bf16 v[184:187], v[24:27], v[128:131], v[184:187]
  v_mfma_f32_32x32x16_bf16 v[80:95], v[132:135], v[108:111], v[80:95]
  s_nop 15
  s_nop 7
  v_lshlrev_b32 v2, 4, v1
  s_lshl_b32 s6, s37, 13
  v_add_u32 v2, s6, v2
  ds_write_b128 v2, v[64:67] offset:4096
  ds_write_b128 v2, v[68:71] offset:5120
  ds_write_b128 v2, v[72:75] offset:6144
  ds_write_b128 v2, v[76:79] offset:7168
  ds_write_b128 v2, v[80:83] offset:8192
  ds_write_b128 v2, v[84:87] offset:9216
  ds_write_b128 v2, v[88:91] offset:10240
  ds_write_b128 v2, v[92:95] offset:11264
  v_and_b32 v2, 31, v1
  v_and_b32 v3, 3, v2
  v_lshrrev_b32 v4, 3, v2
  v_lshl_add_u32 v3, v4, 2, v3
  v_mov_b32 v8, 0
  v_cmp_eq_u32 vcc, 0, v3
  s_nop 1
  v_cndmask_b32 v8, v8, v164, vcc
  v_cmp_eq_u32 vcc, 1, v3
  s_nop 1
  v_cndmask_b32 v8, v8, v165, vcc
  v_cmp_eq_u32 vcc, 2, v3
  s_nop 1
  v_cndmask_b32 v8, v8, v166, vcc
  v_cmp_eq_u32 vcc, 3, v3
  s_nop 1
  v_cndmask_b32 v8, v8, v167, vcc
  v_cmp_eq_u32 vcc, 4, v3
  s_nop 1
  v_cndmask_b32 v8, v8, v168, vcc
  v_cmp_eq_u32 vcc, 5, v3
  s_nop 1
  v_cndmask_b32 v8, v8, v169, vcc
  v_cmp_eq_u32 vcc, 6, v3
  s_nop 1
  v_cndmask_b32 v8, v8, v170, vcc
  v_cmp_eq_u32 vcc, 7, v3
  s_nop 1
  v_cndmask_b32 v8, v8, v171, vcc
  v_cmp_eq_u32 vcc, 8, v3
  s_nop 1
  v_cndmask_b32 v8, v8, v172, vcc
  v_cmp_eq_u32 vcc, 9, v3
  s_nop 1
  v_cndmask_b32 v8, v8, v173, vcc
  v_cmp_eq_u32 vcc, 10, v3
  s_nop 1
  v_cndmask_b32 v8, v8, v174, vcc
  v_cmp_eq_u32 vcc, 11, v3
  s_nop 1
  v_cndmask_b32 v8, v8, v175, vcc
  v_cmp_eq_u32 vcc, 12, v3
  s_nop 1
  v_cndmask_b32 v8, v8, v176, vcc
  v_cmp_eq_u32 vcc, 13, v3
  s_nop 1
  v_cndmask_b32 v8, v8, v177, vcc
  v_cmp_eq_u32 vcc, 14, v3
  s_nop 1
  v_cndmask_b32 v8, v8, v178, vcc
  v_cmp_eq_u32 vcc, 15, v3
  s_nop 1
  v_cndmask_b32 v8, v8, v179, vcc
  v_bfe_u32 v4, v2, 2, 1
  v_lshrrev_b32 v5, 5, v1
  v_cmp_eq_u32 vcc, v4, v5
  s_lshl_b32 s6, s4, 8
  s_lshl_b32 s7, s5, 7
  s_add_u32 s6, s6, s7
  v_lshlrev_b32 v6, 2, v2
  v_add_u32 v6, s6, v6
  s_and_saveexec_b64 s[58:59], vcc
  ds_write_b32 v6, v8 offset:512
  s_mov_b64 exec, s[58:59]
  v_lshlrev_b32 v6, 2, v1
  v_add_u32 v6, s6, v6
  s_mov_b64 exec, 0xffff
  ds_write_b32 v6, v180 offset:0
  ds_write_b32 v6, v181 offset:64
  s_mov_b64 exec, -1
  s_lshl_b32 s6, s5, 8
  s_lshl_b32 s7, s4, 7
  s_add_u32 s6, s6, s7
  v_lshlrev_b32 v6, 2, v1
  v_add_u32 v6, s6, v6
  s_mov_b64 exec, 0xffff
  ds_write_b32 v6, v184 offset:1024
  ds_write_b32 v6, v185 offset:1088
  s_mov_b64 exec, -1
  s_waitcnt lgkmcnt(0)
  s_barrier
  v_and_b32 v2, 31, v1
  v_lshlrev_b32 v4, 2, v2
  s_lshl_b32 s6, s4, 8
  v_add_u32 v4, s6, v4
  s_xor_b32 s6, s5, 0
  s_lshl_b32 s6, s6, 7
  v_add_u32 v7, s6, v4
  ds_read_b32 v24, v7 offset:0
  ds_read_b32 v25, v7 offset:512
  v_lshrrev_b32 v3, 5, v1
  v_lshlrev_b32 v5, 4, v3
  s_lshl_b32 s6, s5, 8
  v_add_u32 v5, s6, v5
  s_xor_b32 s6, s4, 0
  s_lshl_b32 s6, s6, 7
  v_add_u32 v6, s6, v5
  ds_read_b128 v[96:99], v6 offset:1024
  ds_read_b128 v[100:103], v6 offset:1056
  ds_read_b128 v[104:107], v6 offset:1088
  ds_read_b128 v[108:111], v6 offset:1120
  s_xor_b32 s6, s4, 1
  s_lshl_b32 s6, s6, 7
  v_add_u32 v6, s6, v5
  ds_read_b128 v[112:115], v6 offset:1024
  ds_read_b128 v[116:119], v6 offset:1056
  ds_read_b128 v[120:123], v6 offset:1088
  ds_read_b128 v[124:127], v6 offset:1120
  s_waitcnt lgkmcnt(0)
  v_mul_f32 v24, 0x3b000000, v24
  v_mul_f32 v25, 0x3b000000, v25
  v_fma_f32 v25, -v24, v24, v25
  v_max_f32 v25, 0, v25
  v_cvt_pk_bf16_f32 v24, v24, v24
  v_lshlrev_b32 v24, 16, v24
  v_cvt_pk_bf16_f32 v25, v25, v25
  v_lshlrev_b32 v25, 16, v25
  v_add_f32 v25, 0x3727c5ac, v25
  v_cvt_pk_bf16_f32 v25, v25, v25
  v_lshlrev_b32 v25, 16, v25
  v_sqrt_f32 v25, v25
  s_nop 0
  v_cvt_pk_bf16_f32 v25, v25, v25
  v_lshlrev_b32 v25, 16, v25
  v_rcp_f32 v8, v25
  s_nop 0
  v_mul_f32 v10, v24, v8
  s_lshl_b32 s34, s31, 2
  s_lshl_b32 s6, s4, 1
  s_add_u32 s34, s34, s6
  s_lshl_b32 s34, s34, 5
  s_lshl_b32 s6, s32, 3
  s_add_u32 s34, s34, s6
  s_lshl_b32 s6, s5, 2
  s_add_u32 s34, s34, s6
  s_lshl_b32 s34, s34, 10
  v_lshlrev_b32 v6, 4, v1
  s_xor_b32 s35, s5, 0
  s_mul_i32 s35, s35, 32768
  s_add_u32 s35, s35, s34
  s_xor_b32 s36, s4, 0
  s_lshl_b32 s36, s36, 11
  s_add_u32 s36, s36, s35
  v_pk_mul_f32 v[132:133], v[32:33], v[8:9] op_sel_hi:[1,0]
  v_pk_mul_f32 v[134:135], v[34:35], v[8:9] op_sel_hi:[1,0]
  v_pk_mul_f32 v[136:137], v[36:37], v[8:9] op_sel_hi:[1,0]
  v_pk_mul_f32 v[138:139], v[38:39], v[8:9] op_sel_hi:[1,0]
  v_pk_fma_f32 v[132:133], v[96:97], v[10:11], v[132:133] op_sel_hi:[1,0,1] neg_lo:[0,1,0] neg_hi:[0,1,0]
  v_pk_fma_f32 v[134:135], v[98:99], v[10:11], v[134:135] op_sel_hi:[1,0,1] neg_lo:[0,1,0] neg_hi:[0,1,0]
  v_pk_fma_f32 v[136:137], v[100:101], v[10:11], v[136:137] op_sel_hi:[1,0,1] neg_lo:[0,1,0] neg_hi:[0,1,0]
  v_pk_fma_f32 v[138:139], v[102:103], v[10:11], v[138:139] op_sel_hi:[1,0,1] neg_lo:[0,1,0] neg_hi:[0,1,0]
  v_cvt_pk_bf16_f32 v148, v132, v133
  v_cvt_pk_bf16_f32 v149, v134, v135
  v_cvt_pk_bf16_f32 v150, v136, v137
  v_cvt_pk_bf16_f32 v151, v138, v139
  v_lshlrev_b32 v132, 16, v148
  v_and_b32 v133, 0xffff0000, v148
  v_lshlrev_b32 v134, 16, v149
  v_and_b32 v135, 0xffff0000, v149
  v_lshlrev_b32 v136, 16, v150
  v_and_b32 v137, 0xffff0000, v150
  v_lshlrev_b32 v138, 16, v151
  v_and_b32 v139, 0xffff0000, v151
  v_min_f32 v140, 0, v132
  v_min_f32 v141, 0, v133
  v_min_f32 v142, 0, v134
  v_min_f32 v143, 0, v135
  v_min_f32 v144, 0, v136
  v_min_f32 v145, 0, v137
  v_min_f32 v146, 0, v138
  v_min_f32 v147, 0, v139
  v_pk_add_f32 v[132:133], v[132:133], v[140:141] neg_lo:[0,1] neg_hi:[0,1]
  v_pk_add_f32 v[134:135], v[134:135], v[142:143] neg_lo:[0,1] neg_hi:[0,1]
  v_pk_add_f32 v[136:137], v[136:137], v[144:145] neg_lo:[0,1] neg_hi:[0,1]
  v_pk_add_f32 v[138:139], v[138:139], v[146:147] neg_lo:[0,1] neg_hi:[0,1]
  v_pk_mul_f32 v[140:141], v[140:141], s[52:53]
  v_pk_mul_f32 v[142:143], v[142:143], s[52:53]
  v_pk_mul_f32 v[144:145], v[144:145], s[52:53]
  v_pk_mul_f32 v[146:147], v[146:147], s[52:53]
  v_exp_f32 v140, v140
  v_exp_f32 v141, v141
  v_exp_f32 v142, v142
  v_exp_f32 v143, v143
  v_exp_f32 v144, v144
  v_exp_f32 v145, v145
  v_exp_f32 v146, v146
  v_exp_f32 v147, v147
  v_pk_add_f32 v[132:133], v[132:133], s[56:57]
  v_pk_add_f32 v[134:135], v[134:135], s[56:57]
  v_pk_add_f32 v[136:137], v[136:137], s[56:57]
  v_pk_add_f32 v[138:139], v[138:139], s[56:57]
  v_pk_add_f32 v[132:133], v[132:133], v[140:141]
  v_pk_add_f32 v[134:135], v[134:135], v[142:143]
  v_pk_add_f32 v[136:137], v[136:137], v[144:145]
  v_pk_add_f32 v[138:139], v[138:139], v[146:147]
  v_cvt_pk_bf16_f32 v128, v132, v133
  v_cvt_pk_bf16_f32 v129, v134, v135
  v_cvt_pk_bf16_f32 v130, v136, v137
  v_cvt_pk_bf16_f32 v131, v138, v139
  s_add_u32 s7, s36, 0
  buffer_store_dwordx4 v[128:131], v6, s[16:19], s7 offen
  v_pk_mul_f32 v[132:133], v[40:41], v[8:9] op_sel_hi:[1,0]
  v_pk_mul_f32 v[134:135], v[42:43], v[8:9] op_sel_hi:[1,0]
  v_pk_mul_f32 v[136:137], v[44:45], v[8:9] op_sel_hi:[1,0]
  v_pk_mul_f32 v[138:139], v[46:47], v[8:9] op_sel_hi:[1,0]
  v_pk_fma_f32 v[132:133], v[104:105], v[10:11], v[132:133] op_sel_hi:[1,0,1] neg_lo:[0,1,0] neg_hi:[0,1,0]
  v_pk_fma_f32 v[134:135], v[106:107], v[10:11], v[134:135] op_sel_hi:[1,0,1] neg_lo:[0,1,0] neg_hi:[0,1,0]
  v_pk_fma_f32 v[136:137], v[108:109], v[10:11], v[136:137] op_sel_hi:[1,0,1] neg_lo:[0,1,0] neg_hi:[0,1,0]
  v_pk_fma_f32 v[138:139], v[110:111], v[10:11], v[138:139] op_sel_hi:[1,0,1] neg_lo:[0,1,0] neg_hi:[0,1,0]
  v_cvt_pk_bf16_f32 v148, v132, v133
  v_cvt_pk_bf16_f32 v149, v134, v135
  v_cvt_pk_bf16_f32 v150, v136, v137
  v_cvt_pk_bf16_f32 v151, v138, v139
  v_lshlrev_b32 v132, 16, v148
  v_and_b32 v133, 0xffff0000, v148
  v_lshlrev_b32 v134, 16, v149
  v_and_b32 v135, 0xffff0000, v149
  v_lshlrev_b32 v136, 16, v150
  v_and_b32 v137, 0xffff0000, v150
  v_lshlrev_b32 v138, 16, v151
  v_and_b32 v139, 0xffff0000, v151
  v_min_f32 v140, 0, v132
  v_min_f32 v141, 0, v133
  v_min_f32 v142, 0, v134
  v_min_f32 v143, 0, v135
  v_min_f32 v144, 0, v136
  v_min_f32 v145, 0, v137
  v_min_f32 v146, 0, v138
  v_min_f32 v147, 0, v139
  v_pk_add_f32 v[132:133], v[132:133], v[140:141] neg_lo:[0,1] neg_hi:[0,1]
  v_pk_add_f32 v[134:135], v[134:135], v[142:143] neg_lo:[0,1] neg_hi:[0,1]
  v_pk_add_f32 v[136:137], v[136:137], v[144:145] neg_lo:[0,1] neg_hi:[0,1]
  v_pk_add_f32 v[138:139], v[138:139], v[146:147] neg_lo:[0,1] neg_hi:[0,1]
  v_pk_mul_f32 v[140:141], v[140:141], s[52:53]
  v_pk_mul_f32 v[142:143], v[142:143], s[52:53]
  v_pk_mul_f32 v[144:145], v[144:145], s[52:53]
  v_pk_mul_f32 v[146:147], v[146:147], s[52:53]
  v_exp_f32 v140, v140
  v_exp_f32 v141, v141
  v_exp_f32 v142, v142
  v_exp_f32 v143, v143
  v_exp_f32 v144, v144
  v_exp_f32 v145, v145
  v_exp_f32 v146, v146
  v_exp_f32 v147, v147
  v_pk_add_f32 v[132:133], v[132:133], s[56:57]
  v_pk_add_f32 v[134:135], v[134:135], s[56:57]
  v_pk_add_f32 v[136:137], v[136:137], s[56:57]
  v_pk_add_f32 v[138:139], v[138:139], s[56:57]
  v_pk_add_f32 v[132:133], v[132:133], v[140:141]
  v_pk_add_f32 v[134:135], v[134:135], v[142:143]
  v_pk_add_f32 v[136:137], v[136:137], v[144:145]
  v_pk_add_f32 v[138:139], v[138:139], v[146:147]
  v_cvt_pk_bf16_f32 v128, v132, v133
  v_cvt_pk_bf16_f32 v129, v134, v135
  v_cvt_pk_bf16_f32 v130, v136, v137
  v_cvt_pk_bf16_f32 v131, v138, v139
  s_add_u32 s7, s36, 1024
  buffer_store_dwordx4 v[128:131], v6, s[16:19], s7 offen
  s_xor_b32 s36, s4, 1
  s_lshl_b32 s36, s36, 11
  s_add_u32 s36, s36, s35
  v_pk_mul_f32 v[132:133], v[48:49], v[8:9] op_sel_hi:[1,0]
  v_pk_mul_f32 v[134:135], v[50:51], v[8:9] op_sel_hi:[1,0]
  v_pk_mul_f32 v[136:137], v[52:53], v[8:9] op_sel_hi:[1,0]
  v_pk_mul_f32 v[138:139], v[54:55], v[8:9] op_sel_hi:[1,0]
  v_pk_fma_f32 v[132:133], v[112:113], v[10:11], v[132:133] op_sel_hi:[1,0,1] neg_lo:[0,1,0] neg_hi:[0,1,0]
  v_pk_fma_f32 v[134:135], v[114:115], v[10:11], v[134:135] op_sel_hi:[1,0,1] neg_lo:[0,1,0] neg_hi:[0,1,0]
  v_pk_fma_f32 v[136:137], v[116:117], v[10:11], v[136:137] op_sel_hi:[1,0,1] neg_lo:[0,1,0] neg_hi:[0,1,0]
  v_pk_fma_f32 v[138:139], v[118:119], v[10:11], v[138:139] op_sel_hi:[1,0,1] neg_lo:[0,1,0] neg_hi:[0,1,0]
  v_cvt_pk_bf16_f32 v148, v132, v133
  v_cvt_pk_bf16_f32 v149, v134, v135
  v_cvt_pk_bf16_f32 v150, v136, v137
  v_cvt_pk_bf16_f32 v151, v138, v139
  v_lshlrev_b32 v132, 16, v148
  v_and_b32 v133, 0xffff0000, v148
  v_lshlrev_b32 v134, 16, v149
  v_and_b32 v135, 0xffff0000, v149
  v_lshlrev_b32 v136, 16, v150
  v_and_b32 v137, 0xffff0000, v150
  v_lshlrev_b32 v138, 16, v151
  v_and_b32 v139, 0xffff0000, v151
  v_min_f32 v140, 0, v132
  v_min_f32 v141, 0, v133
  v_min_f32 v142, 0, v134
  v_min_f32 v143, 0, v135
  v_min_f32 v144, 0, v136
  v_min_f32 v145, 0, v137
  v_min_f32 v146, 0, v138
  v_min_f32 v147, 0, v139
  v_pk_add_f32 v[132:133], v[132:133], v[140:141] neg_lo:[0,1] neg_hi:[0,1]
  v_pk_add_f32 v[134:135], v[134:135], v[142:143] neg_lo:[0,1] neg_hi:[0,1]
  v_pk_add_f32 v[136:137], v[136:137], v[144:145] neg_lo:[0,1] neg_hi:[0,1]
  v_pk_add_f32 v[138:139], v[138:139], v[146:147] neg_lo:[0,1] neg_hi:[0,1]
  v_pk_mul_f32 v[140:141], v[140:141], s[52:53]
  v_pk_mul_f32 v[142:143], v[142:143], s[52:53]
  v_pk_mul_f32 v[144:145], v[144:145], s[52:53]
  v_pk_mul_f32 v[146:147], v[146:147], s[52:53]
  v_exp_f32 v140, v140
  v_exp_f32 v141, v141
  v_exp_f32 v142, v142
  v_exp_f32 v143, v143
  v_exp_f32 v144, v144
  v_exp_f32 v145, v145
  v_exp_f32 v146, v146
  v_exp_f32 v147, v147
  v_pk_add_f32 v[132:133], v[132:133], s[56:57]
  v_pk_add_f32 v[134:135], v[134:135], s[56:57]
  v_pk_add_f32 v[136:137], v[136:137], s[56:57]
  v_pk_add_f32 v[138:139], v[138:139], s[56:57]
  v_pk_add_f32 v[132:133], v[132:133], v[140:141]
  v_pk_add_f32 v[134:135], v[134:135], v[142:143]
  v_pk_add_f32 v[136:137], v[136:137], v[144:145]
  v_pk_add_f32 v[138:139], v[138:139], v[146:147]
  v_cvt_pk_bf16_f32 v128, v132, v133
  v_cvt_pk_bf16_f32 v129, v134, v135
  v_cvt_pk_bf16_f32 v130, v136, v137
  v_cvt_pk_bf16_f32 v131, v138, v139
  s_add_u32 s7, s36, 0
  buffer_store_dwordx4 v[128:131], v6, s[16:19], s7 offen
  v_pk_mul_f32 v[132:133], v[56:57], v[8:9] op_sel_hi:[1,0]
  v_pk_mul_f32 v[134:135], v[58:59], v[8:9] op_sel_hi:[1,0]
  v_pk_mul_f32 v[136:137], v[60:61], v[8:9] op_sel_hi:[1,0]
  v_pk_mul_f32 v[138:139], v[62:63], v[8:9] op_sel_hi:[1,0]
  v_pk_fma_f32 v[132:133], v[120:121], v[10:11], v[132:133] op_sel_hi:[1,0,1] neg_lo:[0,1,0] neg_hi:[0,1,0]
  v_pk_fma_f32 v[134:135], v[122:123], v[10:11], v[134:135] op_sel_hi:[1,0,1] neg_lo:[0,1,0] neg_hi:[0,1,0]
  v_pk_fma_f32 v[136:137], v[124:125], v[10:11], v[136:137] op_sel_hi:[1,0,1] neg_lo:[0,1,0] neg_hi:[0,1,0]
  v_pk_fma_f32 v[138:139], v[126:127], v[10:11], v[138:139] op_sel_hi:[1,0,1] neg_lo:[0,1,0] neg_hi:[0,1,0]
  v_cvt_pk_bf16_f32 v148, v132, v133
  v_cvt_pk_bf16_f32 v149, v134, v135
  v_cvt_pk_bf16_f32 v150, v136, v137
  v_cvt_pk_bf16_f32 v151, v138, v139
  v_lshlrev_b32 v132, 16, v148
  v_and_b32 v133, 0xffff0000, v148
  v_lshlrev_b32 v134, 16, v149
  v_and_b32 v135, 0xffff0000, v149
  v_lshlrev_b32 v136, 16, v150
  v_and_b32 v137, 0xffff0000, v150
  v_lshlrev_b32 v138, 16, v151
  v_and_b32 v139, 0xffff0000, v151
  v_min_f32 v140, 0, v132
  v_min_f32 v141, 0, v133
  v_min_f32 v142, 0, v134
  v_min_f32 v143, 0, v135
  v_min_f32 v144, 0, v136
  v_min_f32 v145, 0, v137
  v_min_f32 v146, 0, v138
  v_min_f32 v147, 0, v139
  v_pk_add_f32 v[132:133], v[132:133], v[140:141] neg_lo:[0,1] neg_hi:[0,1]
  v_pk_add_f32 v[134:135], v[134:135], v[142:143] neg_lo:[0,1] neg_hi:[0,1]
  v_pk_add_f32 v[136:137], v[136:137], v[144:145] neg_lo:[0,1] neg_hi:[0,1]
  v_pk_add_f32 v[138:139], v[138:139], v[146:147] neg_lo:[0,1] neg_hi:[0,1]
  v_pk_mul_f32 v[140:141], v[140:141], s[52:53]
  v_pk_mul_f32 v[142:143], v[142:143], s[52:53]
  v_pk_mul_f32 v[144:145], v[144:145], s[52:53]
  v_pk_mul_f32 v[146:147], v[146:147], s[52:53]
  v_exp_f32 v140, v140
  v_exp_f32 v141, v141
  v_exp_f32 v142, v142
  v_exp_f32 v143, v143
  v_exp_f32 v144, v144
  v_exp_f32 v145, v145
  v_exp_f32 v146, v146
  v_exp_f32 v147, v147
  v_pk_add_f32 v[132:133], v[132:133], s[56:57]
  v_pk_add_f32 v[134:135], v[134:135], s[56:57]
  v_pk_add_f32 v[136:137], v[136:137], s[56:57]
  v_pk_add_f32 v[138:139], v[138:139], s[56:57]
  v_pk_add_f32 v[132:133], v[132:133], v[140:141]
  v_pk_add_f32 v[134:135], v[134:135], v[142:143]
  v_pk_add_f32 v[136:137], v[136:137], v[144:145]
  v_pk_add_f32 v[138:139], v[138:139], v[146:147]
  v_cvt_pk_bf16_f32 v128, v132, v133
  v_cvt_pk_bf16_f32 v129, v134, v135
  v_cvt_pk_bf16_f32 v130, v136, v137
  v_cvt_pk_bf16_f32 v131, v138, v139
  s_add_u32 s7, s36, 1024
  buffer_store_dwordx4 v[128:131], v6, s[16:19], s7 offen
  s_endpgm
P1_LOADER:
  v_lshrrev_b32 v2, 3, v1
  v_lshlrev_b32 v2, 10, v2
  v_and_b32 v3, 7, v1
  v_lshrrev_b32 v4, 4, v1
  v_xor_b32 v5, v3, v4
  v_lshl_add_u32 v32, v5, 4, v2
  v_xor_b32 v5, 4, v5
  v_lshl_add_u32 v33, v5, 4, v2
  v_and_b32 v3, 15, v1
  v_lshlrev_b32 v5, 2, v4
  v_xor_b32 v10, v3, v5
  s_mov_b32 s6, 3072
  v_mul_lo_u32 v11, v4, s6
  s_lshl_b32 s28, s31, 17
  s_lshl_b32 s6, s37, 15
  s_add_u32 s28, s28, s6
  s_lshl_b32 s30, s37, 12
  s_add_u32 s30, s30, 4096
  s_mul_i32 s29, s37, 49152
  s_mov_b32 s33, 1
  v_mov_b32 v23, 1
  s_cmp_lt_u32 s32, 4
  s_cbranch_scc0 P1_LKV
  v_lshl_add_u32 v34, v10, 4, v11
  s_lshl_b32 s6, s32, 8
  s_add_u32 s29, s29, s6
  s_branch P1_LGO
P1_LKV:
  v_bfe_u32 v2, v10, 2, 1
  v_lshlrev_b32 v2, 10, v2
  v_lshrrev_b32 v3, 3, v10
  v_lshl_add_u32 v2, v3, 6, v2
  v_and_b32 v3, 3, v10
  v_lshl_add_u32 v2, v3, 4, v2
  v_add_u32 v34, v2, v11
  s_lshl_b32 s6, s34, 7
  s_add_u32 s29, s29, s6
  s_add_u32 s29, s29, 1024
P1_LGO:
  s_cmp_lt_u32 s32, 4
  s_cbranch_scc0 P1_LLKV
  s_add_u32 m0, s30, 0
  s_add_u32 s7, s28, 0
  buffer_load_dwordx4 v32, s[8:11], s7 offen lds
  s_add_u32 m0, s30, 1024
  s_add_u32 s7, s28, 8192
  buffer_load_dwordx4 v33, s[8:11], s7 offen lds
  s_add_u32 m0, s30, 2048
  s_add_u32 s7, s28, 16384
  buffer_load_dwordx4 v32, s[8:11], s7 offen lds
  s_add_u32 m0, s30, 3072
  s_add_u32 s7, s28, 24576
  buffer_load_dwordx4 v33, s[8:11], s7 offen lds
  s_add_u32 m0, s30, 16384
  s_add_u32 s7, s29, 0
  buffer_load_dwordx4 v34, s[12:15], s7 offen lds
  s_add_u32 m0, s30, 17408
  s_add_u32 s7, s29, 12288
  buffer_load_dwordx4 v34, s[12:15], s7 offen lds
  s_add_u32 m0, s30, 18432
  s_add_u32 s7, s29, 24576
  buffer_load_dwordx4 v34, s[12:15], s7 offen lds
  s_add_u32 m0, s30, 19456
  s_add_u32 s7, s29, 36864
  buffer_load_dwordx4 v34, s[12:15], s7 offen lds
  s_add_u32 m0, s30, 32768
  s_add_u32 s7, s28, 128
  buffer_load_dwordx4 v32, s[8:11], s7 offen lds
  s_add_u32 m0, s30, 33792
  s_add_u32 s7, s28, 8320
  buffer_load_dwordx4 v33, s[8:11], s7 offen lds
  s_add_u32 m0, s30, 34816
  s_add_u32 s7, s28, 16512
  buffer_load_dwordx4 v32, s[8:11], s7 offen lds
  s_add_u32 m0, s30, 35840
  s_add_u32 s7, s28, 24704
  buffer_load_dwordx4 v33, s[8:11], s7 offen lds
  s_add_u32 m0, s30, 49152
  s_add_u32 s7, s29, 196608
  buffer_load_dwordx4 v34, s[12:15], s7 offen lds
  s_add_u32 m0, s30, 50176
  s_add_u32 s7, s29, 208896
  buffer_load_dwordx4 v34, s[12:15], s7 offen lds
  s_add_u32 m0, s30, 51200
  s_add_u32 s7, s29, 221184
  buffer_load_dwordx4 v34, s[12:15], s7 offen lds
  s_add_u32 m0, s30, 52224
  s_add_u32 s7, s29, 233472
  buffer_load_dwordx4 v34, s[12:15], s7 offen lds
  s_waitcnt vmcnt(8)
  s_barrier
  s_add_u32 m0, s30, 65536
  s_add_u32 s7, s28, 256
  buffer_load_dwordx4 v32, s[8:11], s7 offen lds
  s_add_u32 m0, s30, 66560
  s_add_u32 s7, s28, 8448
  buffer_load_dwordx4 v33, s[8:11], s7 offen lds
  s_add_u32 m0, s30, 67584
  s_add_u32 s7, s28, 16640
  buffer_load_dwordx4 v32, s[8:11], s7 offen lds
  s_add_u32 m0, s30, 68608
  s_add_u32 s7, s28, 24832
  buffer_load_dwordx4 v33, s[8:11], s7 offen lds
  s_add_u32 m0, s30, 81920
  s_add_u32 s7, s29, 393216
  buffer_load_dwordx4 v34, s[12:15], s7 offen lds
  s_add_u32 m0, s30, 82944
  s_add_u32 s7, s29, 405504
  buffer_load_dwordx4 v34, s[12:15], s7 offen lds
  s_add_u32 m0, s30, 83968
  s_add_u32 s7, s29, 417792
  buffer_load_dwordx4 v34, s[12:15], s7 offen lds
  s_add_u32 m0, s30, 84992
  s_add_u32 s7, s29, 430080
  buffer_load_dwordx4 v34, s[12:15], s7 offen lds
  s_add_u32 m0, s30, 98304
  s_add_u32 s7, s28, 384
  buffer_load_dwordx4 v32, s[8:11], s7 offen lds
  s_add_u32 m0, s30, 99328
  s_add_u32 s7, s28, 8576
  buffer_load_dwordx4 v33, s[8:11], s7 offen lds
  s_add_u32 m0, s30, 100352
  s_add_u32 s7, s28, 16768
  buffer_load_dwordx4 v32, s[8:11], s7 offen lds
  s_add_u32 m0, s30, 101376
  s_add_u32 s7, s28, 24960
  buffer_load_dwordx4 v33, s[8:11], s7 offen lds
  s_add_u32 m0, s30, 114688
  s_add_u32 s7, s29, 589824
  buffer_load_dwordx4 v34, s[12:15], s7 offen lds
  s_add_u32 m0, s30, 115712
  s_add_u32 s7, s29, 602112
  buffer_load_dwordx4 v34, s[12:15], s7 offen lds
  s_add_u32 m0, s30, 116736
  s_add_u32 s7, s29, 614400
  buffer_load_dwordx4 v34, s[12:15], s7 offen lds
  s_add_u32 m0, s30, 117760
  s_add_u32 s7, s29, 626688
  buffer_load_dwordx4 v34, s[12:15], s7 offen lds
  s_waitcnt vmcnt(16)
  s_barrier
  s_add_u32 m0, s30, 0
  s_add_u32 s7, s28, 512
  buffer_load_dwordx4 v32, s[8:11], s7 offen lds
  s_add_u32 m0, s30, 1024
  s_add_u32 s7, s28, 8704
  buffer_load_dwordx4 v33, s[8:11], s7 offen lds
  s_add_u32 m0, s30, 2048
  s_add_u32 s7, s28, 16896
  buffer_load_dwordx4 v32, s[8:11], s7 offen lds
  s_add_u32 m0, s30, 3072
  s_add_u32 s7, s28, 25088
  buffer_load_dwordx4 v33, s[8:11], s7 offen lds
  s_add_u32 m0, s30, 16384
  s_add_u32 s7, s29, 786432
  buffer_load_dwordx4 v34, s[12:15], s7 offen lds
  s_add_u32 m0, s30, 17408
  s_add_u32 s7, s29, 798720
  buffer_load_dwordx4 v34, s[12:15], s7 offen lds
  s_add_u32 m0, s30, 18432
  s_add_u32 s7, s29, 811008
  buffer_load_dwordx4 v34, s[12:15], s7 offen lds
  s_add_u32 m0, s30, 19456
  s_add_u32 s7, s29, 823296
  buffer_load_dwordx4 v34, s[12:15], s7 offen lds
  s_waitcnt vmcnt(16)
  s_barrier
  s_add_u32 m0, s30, 32768
  s_add_u32 s7, s28, 640
  buffer_load_dwordx4 v32, s[8:11], s7 offen lds
  s_add_u32 m0, s30, 33792
  s_add_u32 s7, s28, 8832
  buffer_load_dwordx4 v33, s[8:11], s7 offen lds
  s_add_u32 m0, s30, 34816
  s_add_u32 s7, s28, 17024
  buffer_load_dwordx4 v32, s[8:11], s7 offen lds
  s_add_u32 m0, s30, 35840
  s_add_u32 s7, s28, 25216
  buffer_load_dwordx4 v33, s[8:11], s7 offen lds
  s_add_u32 m0, s30, 49152
  s_add_u32 s7, s29, 983040
  buffer_load_dwordx4 v34, s[12:15], s7 offen lds
  s_add_u32 m0, s30, 50176
  s_add_u32 s7, s29, 995328
  buffer_load_dwordx4 v34, s[12:15], s7 offen lds
  s_add_u32 m0, s30, 51200
  s_add_u32 s7, s29, 1007616
  buffer_load_dwordx4 v34, s[12:15], s7 offen lds
  s_add_u32 m0, s30, 52224
  s_add_u32 s7, s29, 1019904
  buffer_load_dwordx4 v34, s[12:15], s7 offen lds
  s_waitcnt vmcnt(16)
  s_barrier
  s_add_u32 m0, s30, 65536
  s_add_u32 s7, s28, 768
  buffer_load_dwordx4 v32, s[8:11], s7 offen lds
  s_add_u32 m0, s30, 66560
  s_add_u32 s7, s28, 8960
  buffer_load_dwordx4 v33, s[8:11], s7 offen lds
  s_add_u32 m0, s30, 67584
  s_add_u32 s7, s28, 17152
  buffer_load_dwordx4 v32, s[8:11], s7 offen lds
  s_add_u32 m0, s30, 68608
  s_add_u32 s7, s28, 25344
  buffer_load_dwordx4 v33, s[8:11], s7 offen lds
  s_add_u32 m0, s30, 81920
  s_add_u32 s7, s29, 1179648
  buffer_load_dwordx4 v34, s[12:15], s7 offen lds
  s_add_u32 m0, s30, 82944
  s_add_u32 s7, s29, 1191936
  buffer_load_dwordx4 v34, s[12:15], s7 offen lds
  s_add_u32 m0, s30, 83968
  s_add_u32 s7, s29, 1204224
  buffer_load_dwordx4 v34, s[12:15], s7 offen lds
  s_add_u32 m0, s30, 84992
  s_add_u32 s7, s29, 1216512
  buffer_load_dwordx4 v34, s[12:15], s7 offen lds
  s_waitcnt vmcnt(16)
  s_barrier
  s_add_u32 m0, s30, 98304
  s_add_u32 s7, s28, 896
  buffer_load_dwordx4 v32, s[8:11], s7 offen lds
  s_add_u32 m0, s30, 99328
  s_add_u32 s7, s28, 9088
  buffer_load_dwordx4 v33, s[8:11], s7 offen lds
  s_add_u32 m0, s30, 100352
  s_add_u32 s7, s28, 17280
  buffer_load_dwordx4 v32, s[8:11], s7 offen lds
  s_add_u32 m0, s30, 101376
  s_add_u32 s7, s28, 25472
  buffer_load_dwordx4 v33, s[8:11], s7 offen lds
  s_add_u32 m0, s30, 114688
  s_add_u32 s7, s29, 1376256
  buffer_load_dwordx4 v34, s[12:15], s7 offen lds
  s_add_u32 m0, s30, 115712
  s_add_u32 s7, s29, 1388544
  buffer_load_dwordx4 v34, s[12:15], s7 offen lds
  s_add_u32 m0, s30, 116736
  s_add_u32 s7, s29, 1400832
  buffer_load_dwordx4 v34, s[12:15], s7 offen lds
  s_add_u32 m0, s30, 117760
  s_add_u32 s7, s29, 1413120
  buffer_load_dwordx4 v34, s[12:15], s7 offen lds
  s_waitcnt vmcnt(16)
  s_barrier
  s_waitcnt vmcnt(8)
  s_barrier
  s_waitcnt vmcnt(0)
  s_barrier
  s_barrier
  v_lshlrev_b32 v2, 4, v1
  s_lshl_b32 s6, s37, 13
  v_add_u32 v2, s6, v2
  ds_read_b128 v[64:67], v2 offset:4096
  ds_read_b128 v[68:71], v2 offset:5120
  ds_read_b128 v[72:75], v2 offset:6144
  ds_read_b128 v[76:79], v2 offset:7168
  ds_read_b128 v[80:83], v2 offset:8192
  ds_read_b128 v[84:87], v2 offset:9216
  ds_read_b128 v[88:91], v2 offset:10240
  ds_read_b128 v[92:95], v2 offset:11264
  v_and_b32 v2, 31, v1
  v_lshlrev_b32 v4, 2, v2
  s_lshl_b32 s6, s4, 8
  v_add_u32 v4, s6, v4
  s_xor_b32 s6, s5, 1
  s_lshl_b32 s6, s6, 7
  v_add_u32 v7, s6, v4
  ds_read_b32 v26, v7 offset:0
  ds_read_b32 v27, v7 offset:512
  v_lshrrev_b32 v3, 5, v1
  v_lshlrev_b32 v5, 4, v3
  s_lshl_b32 s6, s5, 8
  v_add_u32 v5, s6, v5
  s_xor_b32 s6, s4, 0
  s_lshl_b32 s6, s6, 7
  v_add_u32 v6, s6, v5
  ds_read_b128 v[96:99], v6 offset:1024
  ds_read_b128 v[100:103], v6 offset:1056
  ds_read_b128 v[104:107], v6 offset:1088
  ds_read_b128 v[108:111], v6 offset:1120
  s_xor_b32 s6, s4, 1
  s_lshl_b32 s6, s6, 7
  v_add_u32 v6, s6, v5
  ds_read_b128 v[112:115], v6 offset:1024
  ds_read_b128 v[116:119], v6 offset:1056
  ds_read_b128 v[120:123], v6 offset:1088
  ds_read_b128 v[124:127], v6 offset:1120
  s_waitcnt lgkmcnt(0)
  v_mul_f32 v26, 0x3b000000, v26
  v_mul_f32 v27, 0x3b000000, v27
  v_fma_f32 v27, -v26, v26, v27
  v_max_f32 v27, 0, v27
  v_cvt_pk_bf16_f32 v26, v26, v26
  v_lshlrev_b32 v26, 16, v26
  v_cvt_pk_bf16_f32 v27, v27, v27
  v_lshlrev_b32 v27, 16, v27
  v_add_f32 v27, 0x3727c5ac, v27
  v_cvt_pk_bf16_f32 v27, v27, v27
  v_lshlrev_b32 v27, 16, v27
  v_sqrt_f32 v27, v27
  s_nop 0
  v_cvt_pk_bf16_f32 v27, v27, v27
  v_lshlrev_b32 v27, 16, v27
  v_rcp_f32 v12, v27
  s_nop 0
  v_mul_f32 v14, v26, v12
  s_lshl_b32 s34, s31, 2
  s_lshl_b32 s6, s4, 1
  s_add_u32 s34, s34, s6
  s_lshl_b32 s34, s34, 5
  s_lshl_b32 s6, s32, 3
  s_add_u32 s34, s34, s6
  s_lshl_b32 s6, s5, 2
  s_add_u32 s34, s34, s6
  s_lshl_b32 s34, s34, 10
  v_lshlrev_b32 v6, 4, v1
  s_xor_b32 s35, s5, 1
  s_mul_i32 s35, s35, 32768
  s_add_u32 s35, s35, s34
  s_xor_b32 s36, s4, 0
  s_lshl_b32 s36, s36, 11
  s_add_u32 s36, s36, s35
  v_pk_mul_f32 v[132:133], v[64:65], v[12:13] op_sel_hi:[1,0]
  v_pk_mul_f32 v[134:135], v[66:67], v[12:13] op_sel_hi:[1,0]
  v_pk_mul_f32 v[136:137], v[68:69], v[12:13] op_sel_hi:[1,0]
  v_pk_mul_f32 v[138:139], v[70:71], v[12:13] op_sel_hi:[1,0]
  v_pk_fma_f32 v[132:133], v[96:97], v[14:15], v[132:133] op_sel_hi:[1,0,1] neg_lo:[0,1,0] neg_hi:[0,1,0]
  v_pk_fma_f32 v[134:135], v[98:99], v[14:15], v[134:135] op_sel_hi:[1,0,1] neg_lo:[0,1,0] neg_hi:[0,1,0]
  v_pk_fma_f32 v[136:137], v[100:101], v[14:15], v[136:137] op_sel_hi:[1,0,1] neg_lo:[0,1,0] neg_hi:[0,1,0]
  v_pk_fma_f32 v[138:139], v[102:103], v[14:15], v[138:139] op_sel_hi:[1,0,1] neg_lo:[0,1,0] neg_hi:[0,1,0]
  v_cvt_pk_bf16_f32 v148, v132, v133
  v_cvt_pk_bf16_f32 v149, v134, v135
  v_cvt_pk_bf16_f32 v150, v136, v137
  v_cvt_pk_bf16_f32 v151, v138, v139
  v_lshlrev_b32 v132, 16, v148
  v_and_b32 v133, 0xffff0000, v148
  v_lshlrev_b32 v134, 16, v149
  v_and_b32 v135, 0xffff0000, v149
  v_lshlrev_b32 v136, 16, v150
  v_and_b32 v137, 0xffff0000, v150
  v_lshlrev_b32 v138, 16, v151
  v_and_b32 v139, 0xffff0000, v151
  v_min_f32 v140, 0, v132
  v_min_f32 v141, 0, v133
  v_min_f32 v142, 0, v134
  v_min_f32 v143, 0, v135
  v_min_f32 v144, 0, v136
  v_min_f32 v145, 0, v137
  v_min_f32 v146, 0, v138
  v_min_f32 v147, 0, v139
  v_pk_add_f32 v[132:133], v[132:133], v[140:141] neg_lo:[0,1] neg_hi:[0,1]
  v_pk_add_f32 v[134:135], v[134:135], v[142:143] neg_lo:[0,1] neg_hi:[0,1]
  v_pk_add_f32 v[136:137], v[136:137], v[144:145] neg_lo:[0,1] neg_hi:[0,1]
  v_pk_add_f32 v[138:139], v[138:139], v[146:147] neg_lo:[0,1] neg_hi:[0,1]
  v_pk_mul_f32 v[140:141], v[140:141], s[52:53]
  v_pk_mul_f32 v[142:143], v[142:143], s[52:53]
  v_pk_mul_f32 v[144:145], v[144:145], s[52:53]
  v_pk_mul_f32 v[146:147], v[146:147], s[52:53]
  v_exp_f32 v140, v140
  v_exp_f32 v141, v141
  v_exp_f32 v142, v142
  v_exp_f32 v143, v143
  v_exp_f32 v144, v144
  v_exp_f32 v145, v145
  v_exp_f32 v146, v146
  v_exp_f32 v147, v147
  v_pk_add_f32 v[132:133], v[132:133], s[56:57]
  v_pk_add_f32 v[134:135], v[134:135], s[56:57]
  v_pk_add_f32 v[136:137], v[136:137], s[56:57]
  v_pk_add_f32 v[138:139], v[138:139], s[56:57]
  v_pk_add_f32 v[132:133], v[132:133], v[140:141]
  v_pk_add_f32 v[134:135], v[134:135], v[142:143]
  v_pk_add_f32 v[136:137], v[136:137], v[144:145]
  v_pk_add_f32 v[138:139], v[138:139], v[146:147]
  v_cvt_pk_bf16_f32 v128, v132, v133
  v_cvt_pk_bf16_f32 v129, v134, v135
  v_cvt_pk_bf16_f32 v130, v136, v137
  v_cvt_pk_bf16_f32 v131, v138, v139
  s_add_u32 s7, s36, 0
  buffer_store_dwordx4 v[128:131], v6, s[16:19], s7 offen
  v_pk_mul_f32 v[132:133], v[72:73], v[12:13] op_sel_hi:[1,0]
  v_pk_mul_f32 v[134:135], v[74:75], v[12:13] op_sel_hi:[1,0]
  v_pk_mul_f32 v[136:137], v[76:77], v[12:13] op_sel_hi:[1,0]
  v_pk_mul_f32 v[138:139], v[78:79], v[12:13] op_sel_hi:[1,0]
  v_pk_fma_f32 v[132:133], v[104:105], v[14:15], v[132:133] op_sel_hi:[1,0,1] neg_lo:[0,1,0] neg_hi:[0,1,0]
  v_pk_fma_f32 v[134:135], v[106:107], v[14:15], v[134:135] op_sel_hi:[1,0,1] neg_lo:[0,1,0] neg_hi:[0,1,0]
  v_pk_fma_f32 v[136:137], v[108:109], v[14:15], v[136:137] op_sel_hi:[1,0,1] neg_lo:[0,1,0] neg_hi:[0,1,0]
  v_pk_fma_f32 v[138:139], v[110:111], v[14:15], v[138:139] op_sel_hi:[1,0,1] neg_lo:[0,1,0] neg_hi:[0,1,0]
  v_cvt_pk_bf16_f32 v148, v132, v133
  v_cvt_pk_bf16_f32 v149, v134, v135
  v_cvt_pk_bf16_f32 v150, v136, v137
  v_cvt_pk_bf16_f32 v151, v138, v139
  v_lshlrev_b32 v132, 16, v148
  v_and_b32 v133, 0xffff0000, v148
  v_lshlrev_b32 v134, 16, v149
  v_and_b32 v135, 0xffff0000, v149
  v_lshlrev_b32 v136, 16, v150
  v_and_b32 v137, 0xffff0000, v150
  v_lshlrev_b32 v138, 16, v151
  v_and_b32 v139, 0xffff0000, v151
  v_min_f32 v140, 0, v132
  v_min_f32 v141, 0, v133
  v_min_f32 v142, 0, v134
  v_min_f32 v143, 0, v135
  v_min_f32 v144, 0, v136
  v_min_f32 v145, 0, v137
  v_min_f32 v146, 0, v138
  v_min_f32 v147, 0, v139
  v_pk_add_f32 v[132:133], v[132:133], v[140:141] neg_lo:[0,1] neg_hi:[0,1]
  v_pk_add_f32 v[134:135], v[134:135], v[142:143] neg_lo:[0,1] neg_hi:[0,1]
  v_pk_add_f32 v[136:137], v[136:137], v[144:145] neg_lo:[0,1] neg_hi:[0,1]
  v_pk_add_f32 v[138:139], v[138:139], v[146:147] neg_lo:[0,1] neg_hi:[0,1]
  v_pk_mul_f32 v[140:141], v[140:141], s[52:53]
  v_pk_mul_f32 v[142:143], v[142:143], s[52:53]
  v_pk_mul_f32 v[144:145], v[144:145], s[52:53]
  v_pk_mul_f32 v[146:147], v[146:147], s[52:53]
  v_exp_f32 v140, v140
  v_exp_f32 v141, v141
  v_exp_f32 v142, v142
  v_exp_f32 v143, v143
  v_exp_f32 v144, v144
  v_exp_f32 v145, v145
  v_exp_f32 v146, v146
  v_exp_f32 v147, v147
  v_pk_add_f32 v[132:133], v[132:133], s[56:57]
  v_pk_add_f32 v[134:135], v[134:135], s[56:57]
  v_pk_add_f32 v[136:137], v[136:137], s[56:57]
  v_pk_add_f32 v[138:139], v[138:139], s[56:57]
  v_pk_add_f32 v[132:133], v[132:133], v[140:141]
  v_pk_add_f32 v[134:135], v[134:135], v[142:143]
  v_pk_add_f32 v[136:137], v[136:137], v[144:145]
  v_pk_add_f32 v[138:139], v[138:139], v[146:147]
  v_cvt_pk_bf16_f32 v128, v132, v133
  v_cvt_pk_bf16_f32 v129, v134, v135
  v_cvt_pk_bf16_f32 v130, v136, v137
  v_cvt_pk_bf16_f32 v131, v138, v139
  s_add_u32 s7, s36, 1024
  buffer_store_dwordx4 v[128:131], v6, s[16:19], s7 offen
  s_xor_b32 s36, s4, 1
  s_lshl_b32 s36, s36, 11
  s_add_u32 s36, s36, s35
  v_pk_mul_f32 v[132:133], v[80:81], v[12:13] op_sel_hi:[1,0]
  v_pk_mul_f32 v[134:135], v[82:83], v[12:13] op_sel_hi:[1,0]
  v_pk_mul_f32 v[136:137], v[84:85], v[12:13] op_sel_hi:[1,0]
  v_pk_mul_f32 v[138:139], v[86:87], v[12:13] op_sel_hi:[1,0]
  v_pk_fma_f32 v[132:133], v[112:113], v[14:15], v[132:133] op_sel_hi:[1,0,1] neg_lo:[0,1,0] neg_hi:[0,1,0]
  v_pk_fma_f32 v[134:135], v[114:115], v[14:15], v[134:135] op_sel_hi:[1,0,1] neg_lo:[0,1,0] neg_hi:[0,1,0]
  v_pk_fma_f32 v[136:137], v[116:117], v[14:15], v[136:137] op_sel_hi:[1,0,1] neg_lo:[0,1,0] neg_hi:[0,1,0]
  v_pk_fma_f32 v[138:139], v[118:119], v[14:15], v[138:139] op_sel_hi:[1,0,1] neg_lo:[0,1,0] neg_hi:[0,1,0]
  v_cvt_pk_bf16_f32 v148, v132, v133
  v_cvt_pk_bf16_f32 v149, v134, v135
  v_cvt_pk_bf16_f32 v150, v136, v137
  v_cvt_pk_bf16_f32 v151, v138, v139
  v_lshlrev_b32 v132, 16, v148
  v_and_b32 v133, 0xffff0000, v148
  v_lshlrev_b32 v134, 16, v149
  v_and_b32 v135, 0xffff0000, v149
  v_lshlrev_b32 v136, 16, v150
  v_and_b32 v137, 0xffff0000, v150
  v_lshlrev_b32 v138, 16, v151
  v_and_b32 v139, 0xffff0000, v151
  v_min_f32 v140, 0, v132
  v_min_f32 v141, 0, v133
  v_min_f32 v142, 0, v134
  v_min_f32 v143, 0, v135
  v_min_f32 v144, 0, v136
  v_min_f32 v145, 0, v137
  v_min_f32 v146, 0, v138
  v_min_f32 v147, 0, v139
  v_pk_add_f32 v[132:133], v[132:133], v[140:141] neg_lo:[0,1] neg_hi:[0,1]
  v_pk_add_f32 v[134:135], v[134:135], v[142:143] neg_lo:[0,1] neg_hi:[0,1]
  v_pk_add_f32 v[136:137], v[136:137], v[144:145] neg_lo:[0,1] neg_hi:[0,1]
  v_pk_add_f32 v[138:139], v[138:139], v[146:147] neg_lo:[0,1] neg_hi:[0,1]
  v_pk_mul_f32 v[140:141], v[140:141], s[52:53]
  v_pk_mul_f32 v[142:143], v[142:143], s[52:53]
  v_pk_mul_f32 v[144:145], v[144:145], s[52:53]
  v_pk_mul_f32 v[146:147], v[146:147], s[52:53]
  v_exp_f32 v140, v140
  v_exp_f32 v141, v141
  v_exp_f32 v142, v142
  v_exp_f32 v143, v143
  v_exp_f32 v144, v144
  v_exp_f32 v145, v145
  v_exp_f32 v146, v146
  v_exp_f32 v147, v147
  v_pk_add_f32 v[132:133], v[132:133], s[56:57]
  v_pk_add_f32 v[134:135], v[134:135], s[56:57]
  v_pk_add_f32 v[136:137], v[136:137], s[56:57]
  v_pk_add_f32 v[138:139], v[138:139], s[56:57]
  v_pk_add_f32 v[132:133], v[132:133], v[140:141]
  v_pk_add_f32 v[134:135], v[134:135], v[142:143]
  v_pk_add_f32 v[136:137], v[136:137], v[144:145]
  v_pk_add_f32 v[138:139], v[138:139], v[146:147]
  v_cvt_pk_bf16_f32 v128, v132, v133
  v_cvt_pk_bf16_f32 v129, v134, v135
  v_cvt_pk_bf16_f32 v130, v136, v137
  v_cvt_pk_bf16_f32 v131, v138, v139
  s_add_u32 s7, s36, 0
  buffer_store_dwordx4 v[128:131], v6, s[16:19], s7 offen
  v_pk_mul_f32 v[132:133], v[88:89], v[12:13] op_sel_hi:[1,0]
  v_pk_mul_f32 v[134:135], v[90:91], v[12:13] op_sel_hi:[1,0]
  v_pk_mul_f32 v[136:137], v[92:93], v[12:13] op_sel_hi:[1,0]
  v_pk_mul_f32 v[138:139], v[94:95], v[12:13] op_sel_hi:[1,0]
  v_pk_fma_f32 v[132:133], v[120:121], v[14:15], v[132:133] op_sel_hi:[1,0,1] neg_lo:[0,1,0] neg_hi:[0,1,0]
  v_pk_fma_f32 v[134:135], v[122:123], v[14:15], v[134:135] op_sel_hi:[1,0,1] neg_lo:[0,1,0] neg_hi:[0,1,0]
  v_pk_fma_f32 v[136:137], v[124:125], v[14:15], v[136:137] op_sel_hi:[1,0,1] neg_lo:[0,1,0] neg_hi:[0,1,0]
  v_pk_fma_f32 v[138:139], v[126:127], v[14:15], v[138:139] op_sel_hi:[1,0,1] neg_lo:[0,1,0] neg_hi:[0,1,0]
  v_cvt_pk_bf16_f32 v148, v132, v133
  v_cvt_pk_bf16_f32 v149, v134, v135
  v_cvt_pk_bf16_f32 v150, v136, v137
  v_cvt_pk_bf16_f32 v151, v138, v139
  v_lshlrev_b32 v132, 16, v148
  v_and_b32 v133, 0xffff0000, v148
  v_lshlrev_b32 v134, 16, v149
  v_and_b32 v135, 0xffff0000, v149
  v_lshlrev_b32 v136, 16, v150
  v_and_b32 v137, 0xffff0000, v150
  v_lshlrev_b32 v138, 16, v151
  v_and_b32 v139, 0xffff0000, v151
  v_min_f32 v140, 0, v132
  v_min_f32 v141, 0, v133
  v_min_f32 v142, 0, v134
  v_min_f32 v143, 0, v135
  v_min_f32 v144, 0, v136
  v_min_f32 v145, 0, v137
  v_min_f32 v146, 0, v138
  v_min_f32 v147, 0, v139
  v_pk_add_f32 v[132:133], v[132:133], v[140:141] neg_lo:[0,1] neg_hi:[0,1]
  v_pk_add_f32 v[134:135], v[134:135], v[142:143] neg_lo:[0,1] neg_hi:[0,1]
  v_pk_add_f32 v[136:137], v[136:137], v[144:145] neg_lo:[0,1] neg_hi:[0,1]
  v_pk_add_f32 v[138:139], v[138:139], v[146:147] neg_lo:[0,1] neg_hi:[0,1]
  v_pk_mul_f32 v[140:141], v[140:141], s[52:53]
  v_pk_mul_f32 v[142:143], v[142:143], s[52:53]
  v_pk_mul_f32 v[144:145], v[144:145], s[52:53]
  v_pk_mul_f32 v[146:147], v[146:147], s[52:53]
  v_exp_f32 v140, v140
  v_exp_f32 v141, v141
  v_exp_f32 v142, v142
  v_exp_f32 v143, v143
  v_exp_f32 v144, v144
  v_exp_f32 v145, v145
  v_exp_f32 v146, v146
  v_exp_f32 v147, v147
  v_pk_add_f32 v[132:133], v[132:133], s[56:57]
  v_pk_add_f32 v[134:135], v[134:135], s[56:57]
  v_pk_add_f32 v[136:137], v[136:137], s[56:57]
  v_pk_add_f32 v[138:139], v[138:139], s[56:57]
  v_pk_add_f32 v[132:133], v[132:133], v[140:141]
  v_pk_add_f32 v[134:135], v[134:135], v[142:143]
  v_pk_add_f32 v[136:137], v[136:137], v[144:145]
  v_pk_add_f32 v[138:139], v[138:139], v[146:147]
  v_cvt_pk_bf16_f32 v128, v132, v133
  v_cvt_pk_bf16_f32 v129, v134, v135
  v_cvt_pk_bf16_f32 v130, v136, v137
  v_cvt_pk_bf16_f32 v131, v138, v139
  s_add_u32 s7, s36, 1024
  buffer_store_dwordx4 v[128:131], v6, s[16:19], s7 offen
  s_endpgm
P1_LLKV:
  s_add_u32 m0, s30, 0
  s_add_u32 s7, s28, 0
  buffer_load_dwordx4 v32, s[8:11], s7 offen lds
  s_add_u32 m0, s30, 1024
  s_add_u32 s7, s28, 8192
  buffer_load_dwordx4 v33, s[8:11], s7 offen lds
  s_add_u32 m0, s30, 2048
  s_add_u32 s7, s28, 16384
  buffer_load_dwordx4 v32, s[8:11], s7 offen lds
  s_add_u32 m0, s30, 3072
  s_add_u32 s7, s28, 24576
  buffer_load_dwordx4 v33, s[8:11], s7 offen lds
  s_add_u32 m0, s30, 16384
  s_add_u32 s7, s29, 0
  buffer_load_dwordx4 v34, s[12:15], s7 offen lds
  s_add_u32 m0, s30, 17408
  s_add_u32 s7, s29, 12288
  buffer_load_dwordx4 v34, s[12:15], s7 offen lds
  s_add_u32 m0, s30, 18432
  s_add_u32 s7, s29, 24576
  buffer_load_dwordx4 v34, s[12:15], s7 offen lds
  s_add_u32 m0, s30, 19456
  s_add_u32 s7, s29, 36864
  buffer_load_dwordx4 v34, s[12:15], s7 offen lds
  s_add_u32 m0, s30, 32768
  s_add_u32 s7, s28, 128
  buffer_load_dwordx4 v32, s[8:11], s7 offen lds
  s_add_u32 m0, s30, 33792
  s_add_u32 s7, s28, 8320
  buffer_load_dwordx4 v33, s[8:11], s7 offen lds
  s_add_u32 m0, s30, 34816
  s_add_u32 s7, s28, 16512
  buffer_load_dwordx4 v32, s[8:11], s7 offen lds
  s_add_u32 m0, s30, 35840
  s_add_u32 s7, s28, 24704
  buffer_load_dwordx4 v33, s[8:11], s7 offen lds
  s_add_u32 m0, s30, 49152
  s_add_u32 s7, s29, 196608
  buffer_load_dwordx4 v34, s[12:15], s7 offen lds
  s_add_u32 m0, s30, 50176
  s_add_u32 s7, s29, 208896
  buffer_load_dwordx4 v34, s[12:15], s7 offen lds
  s_add_u32 m0, s30, 51200
  s_add_u32 s7, s29, 221184
  buffer_load_dwordx4 v34, s[12:15], s7 offen lds
  s_add_u32 m0, s30, 52224
  s_add_u32 s7, s29, 233472
  buffer_load_dwordx4 v34, s[12:15], s7 offen lds
  s_cmp_eq_u32 s3, 4
  s_cbranch_scc0 P1_NOTICK
  s_lshl_b32 s6, s34, 2
  v_mov_b32 v3, s6
  s_mov_b64 exec, 1
  buffer_atomic_add v23, v3, s[24:27], 0 offen sc0
  s_mov_b64 exec, -1
P1_NOTICK:
  s_waitcnt vmcnt(8)
  s_barrier
  s_add_u32 m0, s30, 65536
  s_add_u32 s7, s28, 256
  buffer_load_dwordx4 v32, s[8:11], s7 offen lds
  s_add_u32 m0, s30, 66560
  s_add_u32 s7, s28, 8448
  buffer_load_dwordx4 v33, s[8:11], s7 offen lds
  s_add_u32 m0, s30, 67584
  s_add_u32 s7, s28, 16640
  buffer_load_dwordx4 v32, s[8:11], s7 offen lds
  s_add_u32 m0, s30, 68608
  s_add_u32 s7, s28, 24832
  buffer_load_dwordx4 v33, s[8:11], s7 offen lds
  s_add_u32 m0, s30, 81920
  s_add_u32 s7, s29, 393216
  buffer_load_dwordx4 v34, s[12:15], s7 offen lds
  s_add_u32 m0, s30, 82944
  s_add_u32 s7, s29, 405504
  buffer_load_dwordx4 v34, s[12:15], s7 offen lds
  s_add_u32 m0, s30, 83968
  s_add_u32 s7, s29, 417792
  buffer_load_dwordx4 v34, s[12:15], s7 offen lds
  s_add_u32 m0, s30, 84992
  s_add_u32 s7, s29, 430080
  buffer_load_dwordx4 v34, s[12:15], s7 offen lds
  s_add_u32 m0, s30, 98304
  s_add_u32 s7, s28, 384
  buffer_load_dwordx4 v32, s[8:11], s7 offen lds
  s_add_u32 m0, s30, 99328
  s_add_u32 s7, s28, 8576
  buffer_load_dwordx4 v33, s[8:11], s7 offen lds
  s_add_u32 m0, s30, 100352
  s_add_u32 s7, s28, 16768
  buffer_load_dwordx4 v32, s[8:11], s7 offen lds
  s_add_u32 m0, s30, 101376
  s_add_u32 s7, s28, 24960
  buffer_load_dwordx4 v33, s[8:11], s7 offen lds
  s_add_u32 m0, s30, 114688
  s_add_u32 s7, s29, 589824
  buffer_load_dwordx4 v34, s[12:15], s7 offen lds
  s_add_u32 m0, s30, 115712
  s_add_u32 s7, s29, 602112
  buffer_load_dwordx4 v34, s[12:15], s7 offen lds
  s_add_u32 m0, s30, 116736
  s_add_u32 s7, s29, 614400
  buffer_load_dwordx4 v34, s[12:15], s7 offen lds
  s_add_u32 m0, s30, 117760
  s_add_u32 s7, s29, 626688
  buffer_load_dwordx4 v34, s[12:15], s7 offen lds
  s_waitcnt vmcnt(16)
  v_readfirstlane_b32 s33, v23
  s_nop 0
  s_cmp_eq_u32 s33, 0
  s_cbranch_scc0 P1_NOZERO
  s_mul_i32 s6, s34, 4352
  s_add_u32 s6, s6, 0xd40000
  s_add_u32 s80, s50, s6
  s_addc_u32 s81, s51, 0
  s_mov_b32 s82, 4352
  s_mov_b32 s83, 0x20000
  v_mov_b32 v28, 0
  v_mov_b32 v29, 0
  v_mov_b32 v30, 0
  v_mov_b32 v31, 0
  v_lshlrev_b32 v2, 4, v1
  buffer_store_dwordx4 v[28:31], v2, s[80:83], 0 offen offset:0 sc1
  buffer_store_dwordx4 v[28:31], v2, s[80:83], 0 offen offset:1024 sc1
  buffer_store_dwordx4 v[28:31], v2, s[80:83], 0 offen offset:2048 sc1
  buffer_store_dwordx4 v[28:31], v2, s[80:83], 0 offen offset:3072 sc1
  v_add_u32 v2, 4096, v2
  buffer_store_dwordx4 v[28:31], v2, s[80:83], 0 offen sc1
P1_NOZERO:
  s_barrier
  s_add_u32 m0, s30, 0
  s_add_u32 s7, s28, 512
  buffer_load_dwordx4 v32, s[8:11], s7 offen lds
  s_add_u32 m0, s30, 1024
  s_add_u32 s7, s28, 8704
  buffer_load_dwordx4 v33, s[8:11], s7 offen lds
  s_add_u32 m0, s30, 2048
  s_add_u32 s7, s28, 16896
  buffer_load_dwordx4 v32, s[8:11], s7 offen lds
  s_add_u32 m0, s30, 3072
  s_add_u32 s7, s28, 25088
  buffer_load_dwordx4 v33, s[8:11], s7 offen lds
  s_add_u32 m0, s30, 16384
  s_add_u32 s7, s29, 786432
  buffer_load_dwordx4 v34, s[12:15], s7 offen lds
  s_add_u32 m0, s30, 17408
  s_add_u32 s7, s29, 798720
  buffer_load_dwordx4 v34, s[12:15], s7 offen lds
  s_add_u32 m0, s30, 18432
  s_add_u32 s7, s29, 811008
  buffer_load_dwordx4 v34, s[12:15], s7 offen lds
  s_add_u32 m0, s30, 19456
  s_add_u32 s7, s29, 823296
  buffer_load_dwordx4 v34, s[12:15], s7 offen lds
  s_waitcnt vmcnt(16)
  s_barrier
  s_add_u32 m0, s30, 32768
  s_add_u32 s7, s28, 640
  buffer_load_dwordx4 v32, s[8:11], s7 offen lds
  s_add_u32 m0, s30, 33792
  s_add_u32 s7, s28, 8832
  buffer_load_dwordx4 v33, s[8:11], s7 offen lds
  s_add_u32 m0, s30, 34816
  s_add_u32 s7, s28, 17024
  buffer_load_dwordx4 v32, s[8:11], s7 offen lds
  s_add_u32 m0, s30, 35840
  s_add_u32 s7, s28, 25216
  buffer_load_dwordx4 v33, s[8:11], s7 offen lds
  s_add_u32 m0, s30, 49152
  s_add_u32 s7, s29, 983040
  buffer_load_dwordx4 v34, s[12:15], s7 offen lds
  s_add_u32 m0, s30, 50176
  s_add_u32 s7, s29, 995328
  buffer_load_dwordx4 v34, s[12:15], s7 offen lds
  s_add_u32 m0, s30, 51200
  s_add_u32 s7, s29, 1007616
  buffer_load_dwordx4 v34, s[12:15], s7 offen lds
  s_add_u32 m0, s30, 52224
  s_add_u32 s7, s29, 1019904
  buffer_load_dwordx4 v34, s[12:15], s7 offen lds
  s_waitcnt vmcnt(16)
  s_barrier
  s_add_u32 m0, s30, 65536
  s_add_u32 s7, s28, 768
  buffer_load_dwordx4 v32, s[8:11], s7 offen lds
  s_add_u32 m0, s30, 66560
  s_add_u32 s7, s28, 8960
  buffer_load_dwordx4 v33, s[8:11], s7 offen lds
  s_add_u32 m0, s30, 67584
  s_add_u32 s7, s28, 17152
  buffer_load_dwordx4 v32, s[8:11], s7 offen lds
  s_add_u32 m0, s30, 68608
  s_add_u32 s7, s28, 25344
  buffer_load_dwordx4 v33, s[8:11], s7 offen lds
  s_add_u32 m0, s30, 81920
  s_add_u32 s7, s29, 1179648
  buffer_load_dwordx4 v34, s[12:15], s7 offen lds
  s_add_u32 m0, s30, 82944
  s_add_u32 s7, s29, 1191936
  buffer_load_dwordx4 v34, s[12:15], s7 offen lds
  s_add_u32 m0, s30, 83968
  s_add_u32 s7, s29, 1204224
  buffer_load_dwordx4 v34, s[12:15], s7 offen lds
  s_add_u32 m0, s30, 84992
  s_add_u32 s7, s29, 1216512
  buffer_load_dwordx4 v34, s[12:15], s7 offen lds
  s_waitcnt vmcnt(16)
  s_cmp_eq_u32 s33, 0
  s_cbranch_scc0 P1_NOFLAG
  s_lshl_b32 s6, s34, 2
  s_add_u32 s6, s6, 32
  v_mov_b32 v3, s6
  v_mov_b32 v2, 1
  s_mov_b64 exec, 1
  buffer_store_dword v2, v3, s[24:27], 0 offen sc1
  s_mov_b64 exec, -1
P1_NOFLAG:
  s_barrier
  s_add_u32 m0, s30, 98304
  s_add_u32 s7, s28, 896
  buffer_load_dwordx4 v32, s[8:11], s7 offen lds
  s_add_u32 m0, s30, 99328
  s_add_u32 s7, s28, 9088
  buffer_load_dwordx4 v33, s[8:11], s7 offen lds
  s_add_u32 m0, s30, 100352
  s_add_u32 s7, s28, 17280
  buffer_load_dwordx4 v32, s[8:11], s7 offen lds
  s_add_u32 m0, s30, 101376
  s_add_u32 s7, s28, 25472
  buffer_load_dwordx4 v33, s[8:11], s7 offen lds
  s_add_u32 m0, s30, 114688
  s_add_u32 s7, s29, 1376256
  buffer_load_dwordx4 v34, s[12:15], s7 offen lds
  s_add_u32 m0, s30, 115712
  s_add_u32 s7, s29, 1388544
  buffer_load_dwordx4 v34, s[12:15], s7 offen lds
  s_add_u32 m0, s30, 116736
  s_add_u32 s7, s29, 1400832
  buffer_load_dwordx4 v34, s[12:15], s7 offen lds
  s_add_u32 m0, s30, 117760
  s_add_u32 s7, s29, 1413120
  buffer_load_dwordx4 v34, s[12:15], s7 offen lds
  s_waitcnt vmcnt(16)
  s_barrier
  s_waitcnt vmcnt(8)
  s_barrier
  s_waitcnt vmcnt(0)
  s_barrier
  s_barrier
  v_lshlrev_b32 v2, 4, v1
  s_lshl_b32 s6, s37, 13
  v_add_u32 v2, s6, v2
  ds_read_b128 v[64:67], v2 offset:4096
  ds_read_b128 v[68:71], v2 offset:5120
  ds_read_b128 v[72:75], v2 offset:6144
  ds_read_b128 v[76:79], v2 offset:7168
  ds_read_b128 v[80:83], v2 offset:8192
  ds_read_b128 v[84:87], v2 offset:9216
  ds_read_b128 v[88:91], v2 offset:10240
  ds_read_b128 v[92:95], v2 offset:11264
  v_lshlrev_b32 v4, 2, v1
  s_lshl_b32 s6, s4, 8
  v_add_u32 v4, s6, v4
  ds_read_b32 v8, v4 offset:0
  ds_read_b32 v10, v4 offset:512
  v_and_b32 v2, 31, v1
  v_lshlrev_b32 v5, 2, v2
  s_lshl_b32 s6, s5, 8
  v_add_u32 v5, s6, v5
  ds_read_b32 v28, v5 offset:1024
  ds_read_b32 v30, v5 offset:1152
  s_waitcnt lgkmcnt(0)
  s_cmp_eq_u32 s4, 0
  s_cbranch_scc1 P1_NOSWAPB
  v_swap_b32 v64, v80
  v_swap_b32 v65, v81
  v_swap_b32 v66, v82
  v_swap_b32 v67, v83
  v_swap_b32 v68, v84
  v_swap_b32 v69, v85
  v_swap_b32 v70, v86
  v_swap_b32 v71, v87
  v_swap_b32 v72, v88
  v_swap_b32 v73, v89
  v_swap_b32 v74, v90
  v_swap_b32 v75, v91
  v_swap_b32 v76, v92
  v_swap_b32 v77, v93
  v_swap_b32 v78, v94
  v_swap_b32 v79, v95
P1_NOSWAPB:
  v_mul_f32 v8, 0x3b000000, v8
  v_mul_f32 v10, 0x3b000000, v10
  v_fma_f32 v10, -v8, v8, v10
  v_max_f32 v10, 0, v10
  v_cvt_pk_bf16_f32 v8, v8, v8
  v_lshlrev_b32 v8, 16, v8
  v_cvt_pk_bf16_f32 v10, v10, v10
  v_lshlrev_b32 v10, 16, v10
  v_add_f32 v10, 0x3727c5ac, v10
  v_cvt_pk_bf16_f32 v10, v10, v10
  v_lshlrev_b32 v10, 16, v10
  v_sqrt_f32 v10, v10
  s_nop 0
  v_cvt_pk_bf16_f32 v10, v10, v10
  v_lshlrev_b32 v10, 16, v10
  v_rcp_f32 v12, v10
  s_nop 0
  v_mul_f32 v13, v8, v12
  ds_write_b32 v4, v12 offset:1536
  ds_write_b32 v4, v13 offset:2048
  s_waitcnt lgkmcnt(0)
  v_lshrrev_b32 v3, 5, v1
  v_lshlrev_b32 v5, 4, v3
  s_lshl_b32 s6, s4, 8
  v_add_u32 v5, s6, v5
  s_xor_b32 s6, s5, 1
  s_lshl_b32 s6, s6, 7
  v_add_u32 v6, s6, v5
  ds_read_b128 v[96:99], v6 offset:1536
  ds_read_b128 v[112:115], v6 offset:2048
  ds_read_b128 v[100:103], v6 offset:1568
  ds_read_b128 v[116:119], v6 offset:2080
  ds_read_b128 v[104:107], v6 offset:1600
  ds_read_b128 v[120:123], v6 offset:2112
  ds_read_b128 v[108:111], v6 offset:1632
  ds_read_b128 v[124:127], v6 offset:2144
  s_waitcnt lgkmcnt(0)
  v_pk_mul_f32 v[132:133], v[64:65], v[96:97]
  v_pk_mul_f32 v[134:135], v[66:67], v[98:99]
  v_pk_mul_f32 v[136:137], v[68:69], v[100:101]
  v_pk_mul_f32 v[138:139], v[70:71], v[102:103]
  v_pk_fma_f32 v[132:133], v[112:113], v[28:29], v[132:133] op_sel_hi:[1,0,1] neg_lo:[0,1,0] neg_hi:[0,1,0]
  v_pk_fma_f32 v[134:135], v[114:115], v[28:29], v[134:135] op_sel_hi:[1,0,1] neg_lo:[0,1,0] neg_hi:[0,1,0]
  v_pk_fma_f32 v[136:137], v[116:117], v[28:29], v[136:137] op_sel_hi:[1,0,1] neg_lo:[0,1,0] neg_hi:[0,1,0]
  v_pk_fma_f32 v[138:139], v[118:119], v[28:29], v[138:139] op_sel_hi:[1,0,1] neg_lo:[0,1,0] neg_hi:[0,1,0]
  v_cvt_pk_bf16_f32 v148, v132, v133
  v_cvt_pk_bf16_f32 v149, v134, v135
  v_cvt_pk_bf16_f32 v150, v136, v137
  v_cvt_pk_bf16_f32 v151, v138, v139
  v_lshlrev_b32 v132, 16, v148
  v_and_b32 v133, 0xffff0000, v148
  v_lshlrev_b32 v134, 16, v149
  v_and_b32 v135, 0xffff0000, v149
  v_lshlrev_b32 v136, 16, v150
  v_and_b32 v137, 0xffff0000, v150
  v_lshlrev_b32 v138, 16, v151
  v_and_b32 v139, 0xffff0000, v151
  v_min_f32 v140, 0, v132
  v_min_f32 v141, 0, v133
  v_min_f32 v142, 0, v134
  v_min_f32 v143, 0, v135
  v_min_f32 v144, 0, v136
  v_min_f32 v145, 0, v137
  v_min_f32 v146, 0, v138
  v_min_f32 v147, 0, v139
  v_pk_add_f32 v[132:133], v[132:133], v[140:141] neg_lo:[0,1] neg_hi:[0,1]
  v_pk_add_f32 v[134:135], v[134:135], v[142:143] neg_lo:[0,1] neg_hi:[0,1]
  v_pk_add_f32 v[136:137], v[136:137], v[144:145] neg_lo:[0,1] neg_hi:[0,1]
  v_pk_add_f32 v[138:139], v[138:139], v[146:147] neg_lo:[0,1] neg_hi:[0,1]
  v_pk_mul_f32 v[140:141], v[140:141], s[52:53]
  v_pk_mul_f32 v[142:143], v[142:143], s[52:53]
  v_pk_mul_f32 v[144:145], v[144:145], s[52:53]
  v_pk_mul_f32 v[146:147], v[146:147], s[52:53]
  v_exp_f32 v140, v140
  v_exp_f32 v141, v141
  v_exp_f32 v142, v142
  v_exp_f32 v143, v143
  v_exp_f32 v144, v144
  v_exp_f32 v145, v145
  v_exp_f32 v146, v146
  v_exp_f32 v147, v147
  v_pk_add_f32 v[132:133], v[132:133], s[56:57]
  v_pk_add_f32 v[134:135], v[134:135], s[56:57]
  v_pk_add_f32 v[136:137], v[136:137], s[56:57]
  v_pk_add_f32 v[138:139], v[138:139], s[56:57]
  v_pk_add_f32 v[132:133], v[132:133], v[140:141]
  v_pk_add_f32 v[134:135], v[134:135], v[142:143]
  v_pk_add_f32 v[136:137], v[136:137], v[144:145]
  v_pk_add_f32 v[138:139], v[138:139], v[146:147]
  v_cvt_pk_bf16_f32 v188, v132, v133
  v_cvt_pk_bf16_f32 v189, v134, v135
  v_cvt_pk_bf16_f32 v190, v136, v137
  v_cvt_pk_bf16_f32 v191, v138, v139
  v_pk_mul_f32 v[132:133], v[72:73], v[104:105]
  v_pk_mul_f32 v[134:135], v[74:75], v[106:107]
  v_pk_mul_f32 v[136:137], v[76:77], v[108:109]
  v_pk_mul_f32 v[138:139], v[78:79], v[110:111]
  v_pk_fma_f32 v[132:133], v[120:121], v[28:29], v[132:133] op_sel_hi:[1,0,1] neg_lo:[0,1,0] neg_hi:[0,1,0]
  v_pk_fma_f32 v[134:135], v[122:123], v[28:29], v[134:135] op_sel_hi:[1,0,1] neg_lo:[0,1,0] neg_hi:[0,1,0]
  v_pk_fma_f32 v[136:137], v[124:125], v[28:29], v[136:137] op_sel_hi:[1,0,1] neg_lo:[0,1,0] neg_hi:[0,1,0]
  v_pk_fma_f32 v[138:139], v[126:127], v[28:29], v[138:139] op_sel_hi:[1,0,1] neg_lo:[0,1,0] neg_hi:[0,1,0]
  v_cvt_pk_bf16_f32 v148, v132, v133
  v_cvt_pk_bf16_f32 v149, v134, v135
  v_cvt_pk_bf16_f32 v150, v136, v137
  v_cvt_pk_bf16_f32 v151, v138, v139
  v_lshlrev_b32 v132, 16, v148
  v_and_b32 v133, 0xffff0000, v148
  v_lshlrev_b32 v134, 16, v149
  v_and_b32 v135, 0xffff0000, v149
  v_lshlrev_b32 v136, 16, v150
  v_and_b32 v137, 0xffff0000, v150
  v_lshlrev_b32 v138, 16, v151
  v_and_b32 v139, 0xffff0000, v151
  v_min_f32 v140, 0, v132
  v_min_f32 v141, 0, v133
  v_min_f32 v142, 0, v134
  v_min_f32 v143, 0, v135
  v_min_f32 v144, 0, v136
  v_min_f32 v145, 0, v137
  v_min_f32 v146, 0, v138
  v_min_f32 v147, 0, v139
  v_pk_add_f32 v[132:133], v[132:133], v[140:141] neg_lo:[0,1] neg_hi:[0,1]
  v_pk_add_f32 v[134:135], v[134:135], v[142:143] neg_lo:[0,1] neg_hi:[0,1]
  v_pk_add_f32 v[136:137], v[136:137], v[144:145] neg_lo:[0,1] neg_hi:[0,1]
  v_pk_add_f32 v[138:139], v[138:139], v[146:147] neg_lo:[0,1] neg_hi:[0,1]
  v_pk_mul_f32 v[140:141], v[140:141], s[52:53]
  v_pk_mul_f32 v[142:143], v[142:143], s[52:53]
  v_pk_mul_f32 v[144:145], v[144:145], s[52:53]
  v_pk_mul_f32 v[146:147], v[146:147], s[52:53]
  v_exp_f32 v140, v140
  v_exp_f32 v141, v141
  v_exp_f32 v142, v142
  v_exp_f32 v143, v143
  v_exp_f32 v144, v144
  v_exp_f32 v145, v145
  v_exp_f32 v146, v146
  v_exp_f32 v147, v147
  v_pk_add_f32 v[132:133], v[132:133], s[56:57]
  v_pk_add_f32 v[134:135], v[134:135], s[56:57]
  v_pk_add_f32 v[136:137], v[136:137], s[56:57]
  v_pk_add_f32 v[138:139], v[138:139], s[56:57]
  v_pk_add_f32 v[132:133], v[132:133], v[140:141]
  v_pk_add_f32 v[134:135], v[134:135], v[142:143]
  v_pk_add_f32 v[136:137], v[136:137], v[144:145]
  v_pk_add_f32 v[138:139], v[138:139], v[146:147]
  v_cvt_pk_bf16_f32 v192, v132, v133
  v_cvt_pk_bf16_f32 v193, v134, v135
  v_cvt_pk_bf16_f32 v194, v136, v137
  v_cvt_pk_bf16_f32 v195, v138, v139
  v_pk_mul_f32 v[132:133], v[80:81], v[96:97]
  v_pk_mul_f32 v[134:135], v[82:83], v[98:99]
  v_pk_mul_f32 v[136:137], v[84:85], v[100:101]
  v_pk_mul_f32 v[138:139], v[86:87], v[102:103]
  v_pk_fma_f32 v[132:133], v[112:113], v[30:31], v[132:133] op_sel_hi:[1,0,1] neg_lo:[0,1,0] neg_hi:[0,1,0]
  v_pk_fma_f32 v[134:135], v[114:115], v[30:31], v[134:135] op_sel_hi:[1,0,1] neg_lo:[0,1,0] neg_hi:[0,1,0]
  v_pk_fma_f32 v[136:137], v[116:117], v[30:31], v[136:137] op_sel_hi:[1,0,1] neg_lo:[0,1,0] neg_hi:[0,1,0]
  v_pk_fma_f32 v[138:139], v[118:119], v[30:31], v[138:139] op_sel_hi:[1,0,1] neg_lo:[0,1,0] neg_hi:[0,1,0]
  v_cvt_pk_bf16_f32 v196, v132, v133
  v_cvt_pk_bf16_f32 v197, v134, v135
  v_cvt_pk_bf16_f32 v198, v136, v137
  v_cvt_pk_bf16_f32 v199, v138, v139
  v_pk_mul_f32 v[132:133], v[88:89], v[104:105]
  v_pk_mul_f32 v[134:135], v[90:91], v[106:107]
  v_pk_mul_f32 v[136:137], v[92:93], v[108:109]
  v_pk_mul_f32 v[138:139], v[94:95], v[110:111]
  v_pk_fma_f32 v[132:133], v[120:121], v[30:31], v[132:133] op_sel_hi:[1,0,1] neg_lo:[0,1,0] neg_hi:[0,1,0]
  v_pk_fma_f32 v[134:135], v[122:123], v[30:31], v[134:135] op_sel_hi:[1,0,1] neg_lo:[0,1,0] neg_hi:[0,1,0]
  v_pk_fma_f32 v[136:137], v[124:125], v[30:31], v[136:137] op_sel_hi:[1,0,1] neg_lo:[0,1,0] neg_hi:[0,1,0]
  v_pk_fma_f32 v[138:139], v[126:127], v[30:31], v[138:139] op_sel_hi:[1,0,1] neg_lo:[0,1,0] neg_hi:[0,1,0]
  v_cvt_pk_bf16_f32 v200, v132, v133
  v_cvt_pk_bf16_f32 v201, v134, v135
  v_cvt_pk_bf16_f32 v202, v136, v137
  v_cvt_pk_bf16_f32 v203, v138, v139
  v_mov_b32 v24, 0x3f803f80
  v_mov_b32 v25, 0x3f803f80
  v_mov_b32 v26, 0x3f803f80
  v_mov_b32 v27, 0x3f803f80
  s_nop 1
  v_mfma_f32_32x32x16_bf16 v[96:111], v[196:199], v[188:191], 0
  v_mfma_f32_32x32x16_bf16 v[96:111], v[200:203], v[192:195], v[96:111]
  v_mfma_f32_32x32x16_bf16 v[112:127], v[24:27], v[188:191], 0
  v_mfma_f32_32x32x16_bf16 v[112:127], v[24:27], v[192:195], v[112:127]
  v_and_b32 v3, 16, v1
  v_cmp_ne_u32 vcc, 0, v3
  v_lshlrev_b32 v2, 4, v1
  s_lshl_b32 s6, s37, 13
  v_add_u32 v2, s6, v2
  s_nop 15
  v_cndmask_b32 v96, v96, v104, vcc
  v_cndmask_b32 v97, v97, v105, vcc
  v_cndmask_b32 v98, v98, v106, vcc
  v_cndmask_b32 v99, v99, v107, vcc
  v_cndmask_b32 v100, v100, v108, vcc
  v_cndmask_b32 v101, v101, v109, vcc
  v_cndmask_b32 v102, v102, v110, vcc
  v_cndmask_b32 v103, v103, v111, vcc
  v_lshlrev_b32 v2, 4, v1
  s_mul_i32 s6, s3, 2560
  v_add_u32 v2, s6, v2
  v_lshlrev_b32 v6, 2, v1
  v_add_u32 v6, s6, v6
  ds_write_b128 v2, v[96:99] offset:36864
  ds_write_b128 v2, v[100:103] offset:37888
  ds_write_b32 v6, v112 offset:38912
  s_waitcnt lgkmcnt(0)
  s_barrier
  s_endpgm
P1_KV:
  v_and_b32 v2, 31, v1
  v_lshrrev_b32 v3, 5, v1
  v_lshrrev_b32 v4, 1, v2
  v_and_b32 v4, 7, v4
  v_xor_b32 v4, v4, v3
  v_lshlrev_b32 v5, 7, v2
  s_lshl_b32 s6, s4, 13
  s_add_u32 s6, s6, 4096
  v_add_u32 v5, s6, v5
  s_xor_b32 s6, s5, 0
  s_lshl_b32 s6, s6, 12
  v_xor_b32 v6, 0, v4
  v_lshl_add_u32 v6, v6, 4, v5
  v_add_u32 v144, s6, v6
  v_add_u32 v148, 0x10000, v144
  v_xor_b32 v6, 2, v4
  v_lshl_add_u32 v6, v6, 4, v5
  v_add_u32 v145, s6, v6
  v_add_u32 v149, 0x10000, v145
  v_xor_b32 v6, 4, v4
  v_lshl_add_u32 v6, v6, 4, v5
  v_add_u32 v146, s6, v6
  v_add_u32 v150, 0x10000, v146
  v_xor_b32 v6, 6, v4
  v_lshl_add_u32 v6, v6, 4, v5
  v_add_u32 v147, s6, v6
  v_add_u32 v151, 0x10000, v147
  s_xor_b32 s6, s5, 1
  s_lshl_b32 s6, s6, 12
  v_xor_b32 v6, 0, v4
  v_lshl_add_u32 v6, v6, 4, v5
  v_add_u32 v152, s6, v6
  v_add_u32 v156, 0x10000, v152
  v_xor_b32 v6, 2, v4
  v_lshl_add_u32 v6, v6, 4, v5
  v_add_u32 v153, s6, v6
  v_add_u32 v157, 0x10000, v153
  v_xor_b32 v6, 4, v4
  v_lshl_add_u32 v6, v6, 4, v5
  v_add_u32 v154, s6, v6
  v_add_u32 v158, 0x10000, v154
  v_xor_b32 v6, 6, v4
  v_lshl_add_u32 v6, v6, 4, v5
  v_add_u32 v155, s6, v6
  v_add_u32 v159, 0x10000, v155
  v_lshrrev_b32 v2, 4, v1
  v_and_b32 v3, 15, v1
  v_lshrrev_b32 v4, 5, v1
  v_lshlrev_b32 v4, 3, v4
  v_lshrrev_b32 v5, 2, v3
  v_add_u32 v4, v4, v5
  v_lshlrev_b32 v4, 8, v4
  v_and_b32 v6, 1, v2
  v_lshlrev_b32 v6, 1, v6
  v_bfe_u32 v7, v3, 1, 1
  v_add_u32 v6, v6, v7
  s_lshl_b32 s6, s5, 3
  v_add_u32 v6, s6, v6
  v_lshlrev_b32 v7, 2, v5
  v_and_b32 v8, 1, v3
  v_lshlrev_b32 v8, 3, v8
  v_add_u32 v4, 4096, v4
  s_xor_b32 s6, s4, 0
  s_lshl_b32 s6, s6, 2
  v_add_u32 v9, s6, v6
  v_xor_b32 v9, v9, v7
  v_lshlrev_b32 v9, 4, v9
  v_add3_u32 v160, v9, v4, v8
  v_add_u32 v162, 0x10000, v160
  s_xor_b32 s6, s4, 1
  s_lshl_b32 s6, s6, 2
  v_add_u32 v9, s6, v6
  v_xor_b32 v9, v9, v7
  v_lshlrev_b32 v9, 4, v9
  v_add3_u32 v161, v9, v4, v8
  v_add_u32 v163, 0x10000, v161
  v_and_b32 v2, 15, v1
  v_bfe_u32 v3, v1, 4, 1
  v_cmp_eq_u32 vcc, v2, v3
  v_mov_b32 v4, 0x3f803f80
  s_nop 0
  v_cndmask_b32 v24, 0, v4, vcc
  v_cndmask_b32 v25, 0, v4, vcc
  v_cndmask_b32 v26, 0, v4, vcc
  v_cndmask_b32 v27, 0, v4, vcc
  s_barrier
  ds_read_b128 v[96:99], v144 offset:0
  ds_read_b64_tr_b16 v[120:121], v160 offset:16384
  ds_read_b64_tr_b16 v[122:123], v160 offset:17408
  ds_read_b64_tr_b16 v[124:125], v161 offset:16384
  ds_read_b64_tr_b16 v[126:127], v161 offset:17408
  ds_read_b128 v[100:103], v152 offset:0
  ds_read_b128 v[104:107], v145 offset:0
  ds_read_b64_tr_b16 v[128:129], v160 offset:20480
  ds_read_b64_tr_b16 v[130:131], v160 offset:21504
  ds_read_b64_tr_b16 v[132:133], v161 offset:20480
  ds_read_b64_tr_b16 v[134:135], v161 offset:21504
  ds_read_b128 v[108:111], v153 offset:0
  s_waitcnt lgkmcnt(6)
  v_mfma_f32_32x32x16_bf16 v[32:47], v[96:99], v[120:123], 0
  ds_read_b128 v[112:115], v146 offset:0
  ds_read_b64_tr_b16 v[136:137], v160 offset:24576
  v_mfma_f32_32x32x16_bf16 v[164:179], v[96:99], v[96:99], 0
  v_mfma_f32_32x32x16_bf16 v[48:63], v[96:99], v[124:127], 0
  ds_read_b64_tr_b16 v[138:139], v160 offset:25600
  ds_read_b64_tr_b16 v[140:141], v161 offset:24576
  v_mfma_f32_16x16x32_bf16 v[180:183], v[24:27], v[96:99], 0
  v_mfma_f32_32x32x16_bf16 v[64:79], v[100:103], v[120:123], 0
  ds_read_b64_tr_b16 v[142:143], v161 offset:25600
  ds_read_b128 v[116:119], v154 offset:0
  v_mfma_f32_16x16x32_bf16 v[184:187], v[24:27], v[120:123], 0
  v_mfma_f32_32x32x16_bf16 v[80:95], v[100:103], v[124:127], 0
  s_waitcnt lgkmcnt(6)
  v_mfma_f32_32x32x16_bf16 v[32:47], v[104:107], v[128:131], v[32:47]
  ds_read_b128 v[96:99], v147 offset:0
  ds_read_b64_tr_b16 v[120:121], v160 offset:28672
  v_mfma_f32_32x32x16_bf16 v[164:179], v[104:107], v[104:107], v[164:179]
  v_mfma_f32_32x32x16_bf16 v[48:63], v[104:107], v[132:135], v[48:63]
  ds_read_b64_tr_b16 v[122:123], v160 offset:29696
  ds_read_b64_tr_b16 v[124:125], v161 offset:28672
  v_mfma_f32_16x16x32_bf16 v[180:183], v[24:27], v[104:107], v[180:183]
  v_mfma_f32_32x32x16_bf16 v[64:79], v[108:111], v[128:131], v[64:79]
  ds_read_b64_tr_b16 v[126:127], v161 offset:29696
  ds_read_b128 v[100:103], v155 offset:0
  v_mfma_f32_16x16x32_bf16 v[184:187], v[24:27], v[128:131], v[184:187]
  v_mfma_f32_32x32x16_bf16 v[80:95], v[108:111], v[132:135], v[80:95]
  s_waitcnt lgkmcnt(0)
  s_barrier
  v_mfma_f32_32x32x16_bf16 v[32:47], v[112:115], v[136:139], v[32:47]
  ds_read_b128 v[104:107], v144 offset:32768
  ds_read_b64_tr_b16 v[128:129], v160 offset:49152
  v_mfma_f32_32x32x16_bf16 v[164:179], v[112:115], v[112:115], v[164:179]
  v_mfma_f32_32x32x16_bf16 v[48:63], v[112:115], v[140:143], v[48:63]
  ds_read_b64_tr_b16 v[130:131], v160 offset:50176
  ds_read_b64_tr_b16 v[132:133], v161 offset:49152
  v_mfma_f32_16x16x32_bf16 v[180:183], v[24:27], v[112:115], v[180:183]
  v_mfma_f32_32x32x16_bf16 v[64:79], v[116:119], v[136:139], v[64:79]
  ds_read_b64_tr_b16 v[134:135], v161 offset:50176
  ds_read_b128 v[108:111], v152 offset:32768
  v_mfma_f32_16x16x32_bf16 v[184:187], v[24:27], v[136:139], v[184:187]
  v_mfma_f32_32x32x16_bf16 v[80:95], v[116:119], v[140:143], v[80:95]
  s_waitcnt lgkmcnt(6)
  v_mfma_f32_32x32x16_bf16 v[32:47], v[96:99], v[120:123], v[32:47]
  ds_read_b128 v[112:115], v145 offset:32768
  ds_read_b64_tr_b16 v[136:137], v160 offset:53248
  v_mfma_f32_32x32x16_bf16 v[164:179], v[96:99], v[96:99], v[164:179]
  v_mfma_f32_32x32x16_bf16 v[48:63], v[96:99], v[124:127], v[48:63]
  ds_read_b64_tr_b16 v[138:139], v160 offset:54272
  ds_read_b64_tr_b16 v[140:141], v161 offset:53248
  v_mfma_f32_16x16x32_bf16 v[180:183], v[24:27], v[96:99], v[180:183]
  v_mfma_f32_32x32x16_bf16 v[64:79], v[100:103], v[120:123], v[64:79]
  ds_read_b64_tr_b16 v[142:143], v161 offset:54272
  ds_read_b128 v[116:119], v153 offset:32768
  v_mfma_f32_16x16x32_bf16 v[184:187], v[24:27], v[120:123], v[184:187]
  v_mfma_f32_32x32x16_bf16 v[80:95], v[100:103], v[124:127], v[80:95]
  s_waitcnt lgkmcnt(6)
  v_mfma_f32_32x32x16_bf16 v[32:47], v[104:107], v[128:131], v[32:47]
  ds_read_b128 v[96:99], v146 offset:32768
  ds_read_b64_tr_b16 v[120:121], v160 offset:57344
  v_mfma_f32_32x32x16_bf16 v[164:179], v[104:107], v[104:107], v[164:179]
  v_mfma_f32_32x32x16_bf16 v[48:63], v[104:107], v[132:135], v[48:63]
  ds_read_b64_tr_b16 v[122:123], v160 offset:58368
  ds_read_b64_tr_b16 v[124:125], v161 offset:57344
  v_mfma_f32_16x16x32_bf16 v[180:183], v[24:27], v[104:107], v[180:183]
  v_mfma_f32_32x32x16_bf16 v[64:79], v[108:111], v[128:131], v[64:79]
  ds_read_b64_tr_b16 v[126:127], v161 offset:58368
  ds_read_b128 v[100:103], v154 offset:32768
  v_mfma_f32_16x16x32_bf16 v[184:187], v[24:27], v[128:131], v[184:187]
  v_mfma_f32_32x32x16_bf16 v[80:95], v[108:111], v[132:135], v[80:95]
  s_waitcnt lgkmcnt(6)
  v_mfma_f32_32x32x16_bf16 v[32:47], v[112:115], v[136:139], v[32:47]
  ds_read_b128 v[104:107], v147 offset:32768
  ds_read_b64_tr_b16 v[128:129], v160 offset:61440
  v_mfma_f32_32x32x16_bf16 v[164:179], v[112:115], v[112:115], v[164:179]
  v_mfma_f32_32x32x16_bf16 v[48:63], v[112:115], v[140:143], v[48:63]
  ds_read_b64_tr_b16 v[130:131], v160 offset:62464
  ds_read_b64_tr_b16 v[132:133], v161 offset:61440
  v_mfma_f32_16x16x32_bf16 v[180:183], v[24:27], v[112:115], v[180:183]
  v_mfma_f32_32x32x16_bf16 v[64:79], v[116:119], v[136:139], v[64:79]
  ds_read_b64_tr_b16 v[134:135], v161 offset:62464
  ds_read_b128 v[108:111], v155 offset:32768
  v_mfma_f32_16x16x32_bf16 v[184:187], v[24:27], v[136:139], v[184:187]
  v_mfma_f32_32x32x16_bf16 v[80:95], v[116:119], v[140:143], v[80:95]
  s_waitcnt lgkmcnt(0)
  s_barrier
  v_mfma_f32_32x32x16_bf16 v[32:47], v[96:99], v[120:123], v[32:47]
  ds_read_b128 v[112:115], v148 offset:0
  ds_read_b64_tr_b16 v[136:137], v162 offset:16384
  v_mfma_f32_32x32x16_bf16 v[164:179], v[96:99], v[96:99], v[164:179]
  v_mfma_f32_32x32x16_bf16 v[48:63], v[96:99], v[124:127], v[48:63]
  ds_read_b64_tr_b16 v[138:139], v162 offset:17408
  ds_read_b64_tr_b16 v[140:141], v163 offset:16384
  v_mfma_f32_16x16x32_bf16 v[180:183], v[24:27], v[96:99], v[180:183]
  v_mfma_f32_32x32x16_bf16 v[64:79], v[100:103], v[120:123], v[64:79]
  ds_read_b64_tr_b16 v[142:143], v163 offset:17408
  ds_read_b128 v[116:119], v156 offset:0
  v_mfma_f32_16x16x32_bf16 v[184:187], v[24:27], v[120:123], v[184:187]
  v_mfma_f32_32x32x16_bf16 v[80:95], v[100:103], v[124:127], v[80:95]
  s_waitcnt lgkmcnt(6)
  v_mfma_f32_32x32x16_bf16 v[32:47], v[104:107], v[128:131], v[32:47]
  ds_read_b128 v[96:99], v149 offset:0
  ds_read_b64_tr_b16 v[120:121], v162 offset:20480
  v_mfma_f32_32x32x16_bf16 v[164:179], v[104:107], v[104:107], v[164:179]
  v_mfma_f32_32x32x16_bf16 v[48:63], v[104:107], v[132:135], v[48:63]
  ds_read_b64_tr_b16 v[122:123], v162 offset:21504
  ds_read_b64_tr_b16 v[124:125], v163 offset:20480
  v_mfma_f32_16x16x32_bf16 v[180:183], v[24:27], v[104:107], v[180:183]
  v_mfma_f32_32x32x16_bf16 v[64:79], v[108:111], v[128:131], v[64:79]
  ds_read_b64_tr_b16 v[126:127], v163 offset:21504
  ds_read_b128 v[100:103], v157 offset:0
  v_mfma_f32_16x16x32_bf16 v[184:187], v[24:27], v[128:131], v[184:187]
  v_mfma_f32_32x32x16_bf16 v[80:95], v[108:111], v[132:135], v[80:95]
  s_waitcnt lgkmcnt(6)
  v_mfma_f32_32x32x16_bf16 v[32:47], v[112:115], v[136:139], v[32:47]
  ds_read_b128 v[104:107], v150 offset:0
  ds_read_b64_tr_b16 v[128:129], v162 offset:24576
  v_mfma_f32_32x32x16_bf16 v[164:179], v[112:115], v[112:115], v[164:179]
  v_mfma_f32_32x32x16_bf16 v[48:63], v[112:115], v[140:143], v[48:63]
  ds_read_b64_tr_b16 v[130:131], v162 offset:25600
  ds_read_b64_tr_b16 v[132:133], v163 offset:24576
  v_mfma_f32_16x16x32_bf16 v[180:183], v[24:27], v[112:115], v[180:183]
  v_mfma_f32_32x32x16_bf16 v[64:79], v[116:119], v[136:139], v[64:79]
  ds_read_b64_tr_b16 v[134:135], v163 offset:25600
  ds_read_b128 v[108:111], v158 offset:0
  v_mfma_f32_16x16x32_bf16 v[184:187], v[24:27], v[136:139], v[184:187]
  v_mfma_f32_32x32x16_bf16 v[80:95], v[116:119], v[140:143], v[80:95]
  s_waitcnt lgkmcnt(6)
  v_mfma_f32_32x32x16_bf16 v[32:47], v[96:99], v[120:123], v[32:47]
  ds_read_b128 v[112:115], v151 offset:0
  ds_read_b64_tr_b16 v[136:137], v162 offset:28672
  v_mfma_f32_32x32x16_bf16 v[164:179], v[96:99], v[96:99], v[164:179]
  v_mfma_f32_32x32x16_bf16 v[48:63], v[96:99], v[124:127], v[48:63]
  ds_read_b64_tr_b16 v[138:139], v162 offset:29696
  ds_read_b64_tr_b16 v[140:141], v163 offset:28672
  v_mfma_f32_16x16x32_bf16 v[180:183], v[24:27], v[96:99], v[180:183]
  v_mfma_f32_32x32x16_bf16 v[64:79], v[100:103], v[120:123], v[64:79]
  ds_read_b64_tr_b16 v[142:143], v163 offset:29696
  ds_read_b128 v[116:119], v159 offset:0
  v_mfma_f32_16x16x32_bf16 v[184:187], v[24:27], v[120:123], v[184:187]
  v_mfma_f32_32x32x16_bf16 v[80:95], v[100:103], v[124:127], v[80:95]
  s_waitcnt lgkmcnt(0)
  s_barrier
  v_mfma_f32_32x32x16_bf16 v[32:47], v[104:107], v[128:131], v[32:47]
  ds_read_b128 v[96:99], v148 offset:32768
  ds_read_b64_tr_b16 v[120:121], v162 offset:49152
  v_mfma_f32_32x32x16_bf16 v[164:179], v[104:107], v[104:107], v[164:179]
  v_mfma_f32_32x32x16_bf16 v[48:63], v[104:107], v[132:135], v[48:63]
  ds_read_b64_tr_b16 v[122:123], v162 offset:50176
  ds_read_b64_tr_b16 v[124:125], v163 offset:49152
  v_mfma_f32_16x16x32_bf16 v[180:183], v[24:27], v[104:107], v[180:183]
  v_mfma_f32_32x32x16_bf16 v[64:79], v[108:111], v[128:131], v[64:79]
  ds_read_b64_tr_b16 v[126:127], v163 offset:50176
  ds_read_b128 v[100:103], v156 offset:32768
  v_mfma_f32_16x16x32_bf16 v[184:187], v[24:27], v[128:131], v[184:187]
  v_mfma_f32_32x32x16_bf16 v[80:95], v[108:111], v[132:135], v[80:95]
  s_waitcnt lgkmcnt(6)
  v_mfma_f32_32x32x16_bf16 v[32:47], v[112:115], v[136:139], v[32:47]
  ds_read_b128 v[104:107], v149 offset:32768
  ds_read_b64_tr_b16 v[128:129], v162 offset:53248
  v_mfma_f32_32x32x16_bf16 v[164:179], v[112:115], v[112:115], v[164:179]
  v_mfma_f32_32x32x16_bf16 v[48:63], v[112:115], v[140:143], v[48:63]
  ds_read_b64_tr_b16 v[130:131], v162 offset:54272
  ds_read_b64_tr_b16 v[132:133], v163 offset:53248
  v_mfma_f32_16x16x32_bf16 v[180:183], v[24:27], v[112:115], v[180:183]
  v_mfma_f32_32x32x16_bf16 v[64:79], v[116:119], v[136:139], v[64:79]
  ds_read_b64_tr_b16 v[134:135], v163 offset:54272
  ds_read_b128 v[108:111], v157 offset:32768
  v_mfma_f32_16x16x32_bf16 v[184:187], v[24:27], v[136:139], v[184:187]
  v_mfma_f32_32x32x16_bf16 v[80:95], v[116:119], v[140:143], v[80:95]
  s_waitcnt lgkmcnt(6)
  v_mfma_f32_32x32x16_bf16 v[32:47], v[96:99], v[120:123], v[32:47]
  ds_read_b128 v[112:115], v150 offset:32768
  ds_read_b64_tr_b16 v[136:137], v162 offset:57344
  v_mfma_f32_32x32x16_bf16 v[164:179], v[96:99], v[96:99], v[164:179]
  v_mfma_f32_32x32x16_bf16 v[48:63], v[96:99], v[124:127], v[48:63]
  ds_read_b64_tr_b16 v[138:139], v162 offset:58368
  ds_read_b64_tr_b16 v[140:141], v163 offset:57344
  v_mfma_f32_16x16x32_bf16 v[180:183], v[24:27], v[96:99], v[180:183]
  v_mfma_f32_32x32x16_bf16 v[64:79], v[100:103], v[120:123], v[64:79]
  ds_read_b64_tr_b16 v[142:143], v163 offset:58368
  ds_read_b128 v[116:119], v158 offset:32768
  v_mfma_f32_16x16x32_bf16 v[184:187], v[24:27], v[120:123], v[184:187]
  v_mfma_f32_32x32x16_bf16 v[80:95], v[100:103], v[124:127], v[80:95]
  s_waitcnt lgkmcnt(6)
  v_mfma_f32_32x32x16_bf16 v[32:47], v[104:107], v[128:131], v[32:47]
  ds_read_b128 v[96:99], v151 offset:32768
  ds_read_b64_tr_b16 v[120:121], v162 offset:61440
  v_mfma_f32_32x32x16_bf16 v[164:179], v[104:107], v[104:107], v[164:179]
  v_mfma_f32_32x32x16_bf16 v[48:63], v[104:107], v[132:135], v[48:63]
  ds_read_b64_tr_b16 v[122:123], v162 offset:62464
  ds_read_b64_tr_b16 v[124:125], v163 offset:61440
  v_mfma_f32_16x16x32_bf16 v[180:183], v[24:27], v[104:107], v[180:183]
  v_mfma_f32_32x32x16_bf16 v[64:79], v[108:111], v[128:131], v[64:79]
  ds_read_b64_tr_b16 v[126:127], v163 offset:62464
  ds_read_b128 v[100:103], v159 offset:32768
  v_mfma_f32_16x16x32_bf16 v[184:187], v[24:27], v[128:131], v[184:187]
  v_mfma_f32_32x32x16_bf16 v[80:95], v[108:111], v[132:135], v[80:95]
  s_waitcnt lgkmcnt(0)
  s_barrier
  v_mfma_f32_32x32x16_bf16 v[32:47], v[112:115], v[136:139], v[32:47]
  ds_read_b128 v[104:107], v144 offset:0
  ds_read_b64_tr_b16 v[128:129], v160 offset:16384
  v_mfma_f32_32x32x16_bf16 v[164:179], v[112:115], v[112:115], v[164:179]
  v_mfma_f32_32x32x16_bf16 v[48:63], v[112:115], v[140:143], v[48:63]
  ds_read_b64_tr_b16 v[130:131], v160 offset:17408
  ds_read_b64_tr_b16 v[132:133], v161 offset:16384
  v_mfma_f32_16x16x32_bf16 v[180:183], v[24:27], v[112:115], v[180:183]
  v_mfma_f32_32x32x16_bf16 v[64:79], v[116:119], v[136:139], v[64:79]
  ds_read_b64_tr_b16 v[134:135], v161 offset:17408
  ds_read_b128 v[108:111], v152 offset:0
  v_mfma_f32_16x16x32_bf16 v[184:187], v[24:27], v[136:139], v[184:187]
  v_mfma_f32_32x32x16_bf16 v[80:95], v[116:119], v[140:143], v[80:95]
  s_waitcnt lgkmcnt(6)
  v_mfma_f32_32x32x16_bf16 v[32:47], v[96:99], v[120:123], v[32:47]
  ds_read_b128 v[112:115], v145 offset:0
  ds_read_b64_tr_b16 v[136:137], v160 offset:20480
  v_mfma_f32_32x32x16_bf16 v[164:179], v[96:99], v[96:99], v[164:179]
  v_mfma_f32_32x32x16_bf16 v[48:63], v[96:99], v[124:127], v[48:63]
  ds_read_b64_tr_b16 v[138:139], v160 offset:21504
  ds_read_b64_tr_b16 v[140:141], v161 offset:20480
  v_mfma_f32_16x16x32_bf16 v[180:183], v[24:27], v[96:99], v[180:183]
  v_mfma_f32_32x32x16_bf16 v[64:79], v[100:103], v[120:123], v[64:79]
  ds_read_b64_tr_b16 v[142:143], v161 offset:21504
  ds_read_b128 v[116:119], v153 offset:0
  v_mfma_f32_16x16x32_bf16 v[184:187], v[24:27], v[120:123], v[184:187]
  v_mfma_f32_32x32x16_bf16 v[80:95], v[100:103], v[124:127], v[80:95]
  s_waitcnt lgkmcnt(6)
  v_mfma_f32_32x32x16_bf16 v[32:47], v[104:107], v[128:131], v[32:47]
  ds_read_b128 v[96:99], v146 offset:0
  ds_read_b64_tr_b16 v[120:121], v160 offset:24576
  v_mfma_f32_32x32x16_bf16 v[164:179], v[104:107], v[104:107], v[164:179]
  v_mfma_f32_32x32x16_bf16 v[48:63], v[104:107], v[132:135], v[48:63]
  ds_read_b64_tr_b16 v[122:123], v160 offset:25600
  ds_read_b64_tr_b16 v[124:125], v161 offset:24576
  v_mfma_f32_16x16x32_bf16 v[180:183], v[24:27], v[104:107], v[180:183]
  v_mfma_f32_32x32x16_bf16 v[64:79], v[108:111], v[128:131], v[64:79]
  ds_read_b64_tr_b16 v[126:127], v161 offset:25600
  ds_read_b128 v[100:103], v154 offset:0
  v_mfma_f32_16x16x32_bf16 v[184:187], v[24:27], v[128:131], v[184:187]
  v_mfma_f32_32x32x16_bf16 v[80:95], v[108:111], v[132:135], v[80:95]
  s_waitcnt lgkmcnt(6)
  v_mfma_f32_32x32x16_bf16 v[32:47], v[112:115], v[136:139], v[32:47]
  ds_read_b128 v[104:107], v147 offset:0
  ds_read_b64_tr_b16 v[128:129], v160 offset:28672
  v_mfma_f32_32x32x16_bf16 v[164:179], v[112:115], v[112:115], v[164:179]
  v_mfma_f32_32x32x16_bf16 v[48:63], v[112:115], v[140:143], v[48:63]
  ds_read_b64_tr_b16 v[130:131], v160 offset:29696
  ds_read_b64_tr_b16 v[132:133], v161 offset:28672
  v_mfma_f32_16x16x32_bf16 v[180:183], v[24:27], v[112:115], v[180:183]
  v_mfma_f32_32x32x16_bf16 v[64:79], v[116:119], v[136:139], v[64:79]
  ds_read_b64_tr_b16 v[134:135], v161 offset:29696
  ds_read_b128 v[108:111], v155 offset:0
  v_mfma_f32_16x16x32_bf16 v[184:187], v[24:27], v[136:139], v[184:187]
  v_mfma_f32_32x32x16_bf16 v[80:95], v[116:119], v[140:143], v[80:95]
  s_waitcnt lgkmcnt(0)
  s_barrier
  v_mfma_f32_32x32x16_bf16 v[32:47], v[96:99], v[120:123], v[32:47]
  ds_read_b128 v[112:115], v144 offset:32768
  ds_read_b64_tr_b16 v[136:137], v160 offset:49152
  v_mfma_f32_32x32x16_bf16 v[164:179], v[96:99], v[96:99], v[164:179]
  v_mfma_f32_32x32x16_bf16 v[48:63], v[96:99], v[124:127], v[48:63]
  ds_read_b64_tr_b16 v[138:139], v160 offset:50176
  ds_read_b64_tr_b16 v[140:141], v161 offset:49152
  v_mfma_f32_16x16x32_bf16 v[180:183], v[24:27], v[96:99], v[180:183]
  v_mfma_f32_32x32x16_bf16 v[64:79], v[100:103], v[120:123], v[64:79]
  ds_read_b64_tr_b16 v[142:143], v161 offset:50176
  ds_read_b128 v[116:119], v152 offset:32768
  v_mfma_f32_16x16x32_bf16 v[184:187], v[24:27], v[120:123], v[184:187]
  v_mfma_f32_32x32x16_bf16 v[80:95], v[100:103], v[124:127], v[80:95]
  s_waitcnt lgkmcnt(6)
  v_mfma_f32_32x32x16_bf16 v[32:47], v[104:107], v[128:131], v[32:47]
  ds_read_b128 v[96:99], v145 offset:32768
  ds_read_b64_tr_b16 v[120:121], v160 offset:53248
  v_mfma_f32_32x32x16_bf16 v[164:179], v[104:107], v[104:107], v[164:179]
  v_mfma_f32_32x32x16_bf16 v[48:63], v[104:107], v[132:135], v[48:63]
  ds_read_b64_tr_b16 v[122:123], v160 offset:54272
  ds_read_b64_tr_b16 v[124:125], v161 offset:53248
  v_mfma_f32_16x16x32_bf16 v[180:183], v[24:27], v[104:107], v[180:183]
  v_mfma_f32_32x32x16_bf16 v[64:79], v[108:111], v[128:131], v[64:79]
  ds_read_b64_tr_b16 v[126:127], v161 offset:54272
  ds_read_b128 v[100:103], v153 offset:32768
  v_mfma_f32_16x16x32_bf16 v[184:187], v[24:27], v[128:131], v[184:187]
  v_mfma_f32_32x32x16_bf16 v[80:95], v[108:111], v[132:135], v[80:95]
  s_waitcnt lgkmcnt(6)
  v_mfma_f32_32x32x16_bf16 v[32:47], v[112:115], v[136:139], v[32:47]
  ds_read_b128 v[104:107], v146 offset:32768
  ds_read_b64_tr_b16 v[128:129], v160 offset:57344
  v_mfma_f32_32x32x16_bf16 v[164:179], v[112:115], v[112:115], v[164:179]
  v_mfma_f32_32x32x16_bf16 v[48:63], v[112:115], v[140:143], v[48:63]
  ds_read_b64_tr_b16 v[130:131], v160 offset:58368
  ds_read_b64_tr_b16 v[132:133], v161 offset:57344
  v_mfma_f32_16x16x32_bf16 v[180:183], v[24:27], v[112:115], v[180:183]
  v_mfma_f32_32x32x16_bf16 v[64:79], v[116:119], v[136:139], v[64:79]
  ds_read_b64_tr_b16 v[134:135], v161 offset:58368
  ds_read_b128 v[108:111], v154 offset:32768
  v_mfma_f32_16x16x32_bf16 v[184:187], v[24:27], v[136:139], v[184:187]
  v_mfma_f32_32x32x16_bf16 v[80:95], v[116:119], v[140:143], v[80:95]
  s_waitcnt lgkmcnt(6)
  v_mfma_f32_32x32x16_bf16 v[32:47], v[96:99], v[120:123], v[32:47]
  ds_read_b128 v[112:115], v147 offset:32768
  ds_read_b64_tr_b16 v[136:137], v160 offset:61440
  v_mfma_f32_32x32x16_bf16 v[164:179], v[96:99], v[96:99], v[164:179]
  v_mfma_f32_32x32x16_bf16 v[48:63], v[96:99], v[124:127], v[48:63]
  ds_read_b64_tr_b16 v[138:139], v160 offset:62464
  ds_read_b64_tr_b16 v[140:141], v161 offset:61440
  v_mfma_f32_16x16x32_bf16 v[180:183], v[24:27], v[96:99], v[180:183]
  v_mfma_f32_32x32x16_bf16 v[64:79], v[100:103], v[120:123], v[64:79]
  ds_read_b64_tr_b16 v[142:143], v161 offset:62464
  ds_read_b128 v[116:119], v155 offset:32768
  v_mfma_f32_16x16x32_bf16 v[184:187], v[24:27], v[120:123], v[184:187]
  v_mfma_f32_32x32x16_bf16 v[80:95], v[100:103], v[124:127], v[80:95]
  s_waitcnt lgkmcnt(0)
  s_barrier
  v_mfma_f32_32x32x16_bf16 v[32:47], v[104:107], v[128:131], v[32:47]
  ds_read_b128 v[96:99], v148 offset:0
  ds_read_b64_tr_b16 v[120:121], v162 offset:16384
  v_mfma_f32_32x32x16_bf16 v[164:179], v[104:107], v[104:107], v[164:179]
  v_mfma_f32_32x32x16_bf16 v[48:63], v[104:107], v[132:135], v[48:63]
  ds_read_b64_tr_b16 v[122:123], v162 offset:17408
  ds_read_b64_tr_b16 v[124:125], v163 offset:16384
  v_mfma_f32_16x16x32_bf16 v[180:183], v[24:27], v[104:107], v[180:183]
  v_mfma_f32_32x32x16_bf16 v[64:79], v[108:111], v[128:131], v[64:79]
  ds_read_b64_tr_b16 v[126:127], v163 offset:17408
  ds_read_b128 v[100:103], v156 offset:0
  v_mfma_f32_16x16x32_bf16 v[184:187], v[24:27], v[128:131], v[184:187]
  v_mfma_f32_32x32x16_bf16 v[80:95], v[108:111], v[132:135], v[80:95]
  s_waitcnt lgkmcnt(6)
  v_mfma_f32_32x32x16_bf16 v[32:47], v[112:115], v[136:139], v[32:47]
  ds_read_b128 v[104:107], v149 offset:0
  ds_read_b64_tr_b16 v[128:129], v162 offset:20480
  v_mfma_f32_32x32x16_bf16 v[164:179], v[112:115], v[112:115], v[164:179]
  v_mfma_f32_32x32x16_bf16 v[48:63], v[112:115], v[140:143], v[48:63]
  ds_read_b64_tr_b16 v[130:131], v162 offset:21504
  ds_read_b64_tr_b16 v[132:133], v163 offset:20480
  v_mfma_f32_16x16x32_bf16 v[180:183], v[24:27], v[112:115], v[180:183]
  v_mfma_f32_32x32x16_bf16 v[64:79], v[116:119], v[136:139], v[64:79]
  ds_read_b64_tr_b16 v[134:135], v163 offset:21504
  ds_read_b128 v[108:111], v157 offset:0
  v_mfma_f32_16x16x32_bf16 v[184:187], v[24:27], v[136:139], v[184:187]
  v_mfma_f32_32x32x16_bf16 v[80:95], v[116:119], v[140:143], v[80:95]
  s_waitcnt lgkmcnt(6)
  v_mfma_f32_32x32x16_bf16 v[32:47], v[96:99], v[120:123], v[32:47]
  ds_read_b128 v[112:115], v150 offset:0
  ds_read_b64_tr_b16 v[136:137], v162 offset:24576
  v_mfma_f32_32x32x16_bf16 v[164:179], v[96:99], v[96:99], v[164:179]
  v_mfma_f32_32x32x16_bf16 v[48:63], v[96:99], v[124:127], v[48:63]
  ds_read_b64_tr_b16 v[138:139], v162 offset:25600
  ds_read_b64_tr_b16 v[140:141], v163 offset:24576
  v_mfma_f32_16x16x32_bf16 v[180:183], v[24:27], v[96:99], v[180:183]
  v_mfma_f32_32x32x16_bf16 v[64:79], v[100:103], v[120:123], v[64:79]
  ds_read_b64_tr_b16 v[142:143], v163 offset:25600
  ds_read_b128 v[116:119], v158 offset:0
  v_mfma_f32_16x16x32_bf16 v[184:187], v[24:27], v[120:123], v[184:187]
  v_mfma_f32_32x32x16_bf16 v[80:95], v[100:103], v[124:127], v[80:95]
  s_waitcnt lgkmcnt(6)
  v_mfma_f32_32x32x16_bf16 v[32:47], v[104:107], v[128:131], v[32:47]
  ds_read_b128 v[96:99], v151 offset:0
  ds_read_b64_tr_b16 v[120:121], v162 offset:28672
  v_mfma_f32_32x32x16_bf16 v[164:179], v[104:107], v[104:107], v[164:179]
  v_mfma_f32_32x32x16_bf16 v[48:63], v[104:107], v[132:135], v[48:63]
  ds_read_b64_tr_b16 v[122:123], v162 offset:29696
  ds_read_b64_tr_b16 v[124:125], v163 offset:28672
  v_mfma_f32_16x16x32_bf16 v[180:183], v[24:27], v[104:107], v[180:183]
  v_mfma_f32_32x32x16_bf16 v[64:79], v[108:111], v[128:131], v[64:79]
  ds_read_b64_tr_b16 v[126:127], v163 offset:29696
  ds_read_b128 v[100:103], v159 offset:0
  v_mfma_f32_16x16x32_bf16 v[184:187], v[24:27], v[128:131], v[184:187]
  v_mfma_f32_32x32x16_bf16 v[80:95], v[108:111], v[132:135], v[80:95]
  s_waitcnt lgkmcnt(0)
  s_barrier
  v_mfma_f32_32x32x16_bf16 v[32:47], v[112:115], v[136:139], v[32:47]
  ds_read_b128 v[104:107], v148 offset:32768
  ds_read_b64_tr_b16 v[128:129], v162 offset:49152
  v_mfma_f32_32x32x16_bf16 v[164:179], v[112:115], v[112:115], v[164:179]
  v_mfma_f32_32x32x16_bf16 v[48:63], v[112:115], v[140:143], v[48:63]
  ds_read_b64_tr_b16 v[130:131], v162 offset:50176
  ds_read_b64_tr_b16 v[132:133], v163 offset:49152
  v_mfma_f32_16x16x32_bf16 v[180:183], v[24:27], v[112:115], v[180:183]
  v_mfma_f32_32x32x16_bf16 v[64:79], v[116:119], v[136:139], v[64:79]
  ds_read_b64_tr_b16 v[134:135], v163 offset:50176
  ds_read_b128 v[108:111], v156 offset:32768
  v_mfma_f32_16x16x32_bf16 v[184:187], v[24:27], v[136:139], v[184:187]
  v_mfma_f32_32x32x16_bf16 v[80:95], v[116:119], v[140:143], v[80:95]
  s_waitcnt lgkmcnt(6)
  v_mfma_f32_32x32x16_bf16 v[32:47], v[96:99], v[120:123], v[32:47]
  ds_read_b128 v[112:115], v149 offset:32768
  ds_read_b64_tr_b16 v[136:137], v162 offset:53248
  v_mfma_f32_32x32x16_bf16 v[164:179], v[96:99], v[96:99], v[164:179]
  v_mfma_f32_32x32x16_bf16 v[48:63], v[96:99], v[124:127], v[48:63]
  ds_read_b64_tr_b16 v[138:139], v162 offset:54272
  ds_read_b64_tr_b16 v[140:141], v163 offset:53248
  v_mfma_f32_16x16x32_bf16 v[180:183], v[24:27], v[96:99], v[180:183]
  v_mfma_f32_32x32x16_bf16 v[64:79], v[100:103], v[120:123], v[64:79]
  ds_read_b64_tr_b16 v[142:143], v163 offset:54272
  ds_read_b128 v[116:119], v157 offset:32768
  v_mfma_f32_16x16x32_bf16 v[184:187], v[24:27], v[120:123], v[184:187]
  v_mfma_f32_32x32x16_bf16 v[80:95], v[100:103], v[124:127], v[80:95]
  s_waitcnt lgkmcnt(6)
  v_mfma_f32_32x32x16_bf16 v[32:47], v[104:107], v[128:131], v[32:47]
  ds_read_b128 v[96:99], v150 offset:32768
  ds_read_b64_tr_b16 v[120:121], v162 offset:57344
  v_mfma_f32_32x32x16_bf16 v[164:179], v[104:107], v[104:107], v[164:179]
  v_mfma_f32_32x32x16_bf16 v[48:63], v[104:107], v[132:135], v[48:63]
  ds_read_b64_tr_b16 v[122:123], v162 offset:58368
  ds_read_b64_tr_b16 v[124:125], v163 offset:57344
  v_mfma_f32_16x16x32_bf16 v[180:183], v[24:27], v[104:107], v[180:183]
  v_mfma_f32_32x32x16_bf16 v[64:79], v[108:111], v[128:131], v[64:79]
  ds_read_b64_tr_b16 v[126:127], v163 offset:58368
  ds_read_b128 v[100:103], v158 offset:32768
  v_mfma_f32_16x16x32_bf16 v[184:187], v[24:27], v[128:131], v[184:187]
  v_mfma_f32_32x32x16_bf16 v[80:95], v[108:111], v[132:135], v[80:95]
  s_waitcnt lgkmcnt(6)
  v_mfma_f32_32x32x16_bf16 v[32:47], v[112:115], v[136:139], v[32:47]
  ds_read_b128 v[104:107], v151 offset:32768
  ds_read_b64_tr_b16 v[128:129], v162 offset:61440
  v_mfma_f32_32x32x16_bf16 v[164:179], v[112:115], v[112:115], v[164:179]
  v_mfma_f32_32x32x16_bf16 v[48:63], v[112:115], v[140:143], v[48:63]
  ds_read_b64_tr_b16 v[130:131], v162 offset:62464
  ds_read_b64_tr_b16 v[132:133], v163 offset:61440
  v_mfma_f32_16x16x32_bf16 v[180:183], v[24:27], v[112:115], v[180:183]
  v_mfma_f32_32x32x16_bf16 v[64:79], v[116:119], v[136:139], v[64:79]
  ds_read_b64_tr_b16 v[134:135], v163 offset:62464
  ds_read_b128 v[108:111], v159 offset:32768
  v_mfma_f32_16x16x32_bf16 v[184:187], v[24:27], v[136:139], v[184:187]
  v_mfma_f32_32x32x16_bf16 v[80:95], v[116:119], v[140:143], v[80:95]
  s_waitcnt lgkmcnt(6)
  v_mfma_f32_32x32x16_bf16 v[32:47], v[96:99], v[120:123], v[32:47]
  v_mfma_f32_32x32x16_bf16 v[164:179], v[96:99], v[96:99], v[164:179]
  v_mfma_f32_32x32x16_bf16 v[48:63], v[96:99], v[124:127], v[48:63]
  v_mfma_f32_16x16x32_bf16 v[180:183], v[24:27], v[96:99], v[180:183]
  v_mfma_f32_32x32x16_bf16 v[64:79], v[100:103], v[120:123], v[64:79]
  v_mfma_f32_16x16x32_bf16 v[184:187], v[24:27], v[120:123], v[184:187]
  v_mfma_f32_32x32x16_bf16 v[80:95], v[100:103], v[124:127], v[80:95]
  s_waitcnt lgkmcnt(0)
  v_mfma_f32_32x32x16_bf16 v[32:47], v[104:107], v[128:131], v[32:47]
  v_mfma_f32_32x32x16_bf16 v[164:179], v[104:107], v[104:107], v[164:179]
  v_mfma_f32_32x32x16_bf16 v[48:63], v[104:107], v[132:135], v[48:63]
  v_mfma_f32_16x16x32_bf16 v[180:183], v[24:27], v[104:107], v[180:183]
  v_mfma_f32_32x32x16_bf16 v[64:79], v[108:111], v[128:131], v[64:79]
  v_mfma_f32_16x16x32_bf16 v[184:187], v[24:27], v[128:131], v[184:187]
  v_mfma_f32_32x32x16_bf16 v[80:95], v[108:111], v[132:135], v[80:95]
  s_nop 15
  s_nop 7
  v_lshlrev_b32 v2, 4, v1
  s_lshl_b32 s6, s37, 13
  v_add_u32 v2, s6, v2
  ds_write_b128 v2, v[64:67] offset:4096
  ds_write_b128 v2, v[68:71] offset:5120
  ds_write_b128 v2, v[72:75] offset:6144
  ds_write_b128 v2, v[76:79] offset:7168
  ds_write_b128 v2, v[80:83] offset:8192
  ds_write_b128 v2, v[84:87] offset:9216
  ds_write_b128 v2, v[88:91] offset:10240
  ds_write_b128 v2, v[92:95] offset:11264
  v_and_b32 v2, 31, v1
  v_and_b32 v3, 3, v2
  v_lshrrev_b32 v4, 3, v2
  v_lshl_add_u32 v3, v4, 2, v3
  v_mov_b32 v8, 0
  v_cmp_eq_u32 vcc, 0, v3
  s_nop 1
  v_cndmask_b32 v8, v8, v164, vcc
  v_cmp_eq_u32 vcc, 1, v3
  s_nop 1
  v_cndmask_b32 v8, v8, v165, vcc
  v_cmp_eq_u32 vcc, 2, v3
  s_nop 1
  v_cndmask_b32 v8, v8, v166, vcc
  v_cmp_eq_u32 vcc, 3, v3
  s_nop 1
  v_cndmask_b32 v8, v8, v167, vcc
  v_cmp_eq_u32 vcc, 4, v3
  s_nop 1
  v_cndmask_b32 v8, v8, v168, vcc
  v_cmp_eq_u32 vcc, 5, v3
  s_nop 1
  v_cndmask_b32 v8, v8, v169, vcc
  v_cmp_eq_u32 vcc, 6, v3
  s_nop 1
  v_cndmask_b32 v8, v8, v170, vcc
  v_cmp_eq_u32 vcc, 7, v3
  s_nop 1
  v_cndmask_b32 v8, v8, v171, vcc
  v_cmp_eq_u32 vcc, 8, v3
  s_nop 1
  v_cndmask_b32 v8, v8, v172, vcc
  v_cmp_eq_u32 vcc, 9, v3
  s_nop 1
  v_cndmask_b32 v8, v8, v173, vcc
  v_cmp_eq_u32 vcc, 10, v3
  s_nop 1
  v_cndmask_b32 v8, v8, v174, vcc
  v_cmp_eq_u32 vcc, 11, v3
  s_nop 1
  v_cndmask_b32 v8, v8, v175, vcc
  v_cmp_eq_u32 vcc, 12, v3
  s_nop 1
  v_cndmask_b32 v8, v8, v176, vcc
  v_cmp_eq_u32 vcc, 13, v3
  s_nop 1
  v_cndmask_b32 v8, v8, v177, vcc
  v_cmp_eq_u32 vcc, 14, v3
  s_nop 1
  v_cndmask_b32 v8, v8, v178, vcc
  v_cmp_eq_u32 vcc, 15, v3
  s_nop 1
  v_cndmask_b32 v8, v8, v179, vcc
  v_bfe_u32 v4, v2, 2, 1
  v_lshrrev_b32 v5, 5, v1
  v_cmp_eq_u32 vcc, v4, v5
  s_lshl_b32 s6, s4, 8
  s_lshl_b32 s7, s5, 7
  s_add_u32 s6, s6, s7
  v_lshlrev_b32 v6, 2, v2
  v_add_u32 v6, s6, v6
  s_and_saveexec_b64 s[58:59], vcc
  ds_write_b32 v6, v8 offset:512
  s_mov_b64 exec, s[58:59]
  v_lshlrev_b32 v6, 2, v1
  v_add_u32 v6, s6, v6
  s_mov_b64 exec, 0xffff
  ds_write_b32 v6, v180 offset:0
  ds_write_b32 v6, v181 offset:64
  s_mov_b64 exec, -1
  s_lshl_b32 s6, s5, 8
  s_lshl_b32 s7, s4, 7
  s_add_u32 s6, s6, s7
  v_lshlrev_b32 v6, 2, v1
  v_add_u32 v6, s6, v6
  s_mov_b64 exec, 0xffff
  ds_write_b32 v6, v184 offset:1024
  ds_write_b32 v6, v185 offset:1088
  s_mov_b64 exec, -1
  s_waitcnt lgkmcnt(0)
  s_barrier
  s_lshl_b32 s6, s34, 2
  s_add_u32 s6, s6, 32
  v_mov_b32 v7, s6
  buffer_load_dword v23, v7, s[24:27], 0 offen sc1
  v_lshlrev_b32 v4, 2, v1
  s_lshl_b32 s6, s4, 8
  v_add_u32 v4, s6, v4
  ds_read_b32 v8, v4 offset:0
  ds_read_b32 v10, v4 offset:512
  v_and_b32 v2, 31, v1
  v_lshlrev_b32 v5, 2, v2
  s_lshl_b32 s6, s5, 8
  v_add_u32 v5, s6, v5
  ds_read_b32 v28, v5 offset:1024
  ds_read_b32 v30, v5 offset:1152
  s_waitcnt lgkmcnt(0)
  s_cmp_eq_u32 s4, 0
  s_cbranch_scc1 P1_NOSWAPA
  v_swap_b32 v32, v48
  v_swap_b32 v33, v49
  v_swap_b32 v34, v50
  v_swap_b32 v35, v51
  v_swap_b32 v36, v52
  v_swap_b32 v37, v53
  v_swap_b32 v38, v54
  v_swap_b32 v39, v55
  v_swap_b32 v40, v56
  v_swap_b32 v41, v57
  v_swap_b32 v42, v58
  v_swap_b32 v43, v59
  v_swap_b32 v44, v60
  v_swap_b32 v45, v61
  v_swap_b32 v46, v62
  v_swap_b32 v47, v63
P1_NOSWAPA:
  v_mul_f32 v8, 0x3b000000, v8
  v_mul_f32 v10, 0x3b000000, v10
  v_fma_f32 v10, -v8, v8, v10
  v_max_f32 v10, 0, v10
  v_cvt_pk_bf16_f32 v8, v8, v8
  v_lshlrev_b32 v8, 16, v8
  v_cvt_pk_bf16_f32 v10, v10, v10
  v_lshlrev_b32 v10, 16, v10
  v_add_f32 v10, 0x3727c5ac, v10
  v_cvt_pk_bf16_f32 v10, v10, v10
  v_lshlrev_b32 v10, 16, v10
  v_sqrt_f32 v10, v10
  s_nop 0
  v_cvt_pk_bf16_f32 v10, v10, v10
  v_lshlrev_b32 v10, 16, v10
  v_rcp_f32 v12, v10
  s_nop 0
  v_mul_f32 v13, v8, v12
  ds_write_b32 v4, v12 offset:1536
  ds_write_b32 v4, v13 offset:2048
  s_waitcnt lgkmcnt(0)
  v_lshrrev_b32 v3, 5, v1
  v_lshlrev_b32 v5, 4, v3
  s_lshl_b32 s6, s4, 8
  v_add_u32 v5, s6, v5
  s_xor_b32 s6, s5, 0
  s_lshl_b32 s6, s6, 7
  v_add_u32 v6, s6, v5
  ds_read_b128 v[96:99], v6 offset:1536
  ds_read_b128 v[112:115], v6 offset:2048
  ds_read_b128 v[100:103], v6 offset:1568
  ds_read_b128 v[116:119], v6 offset:2080
  ds_read_b128 v[104:107], v6 offset:1600
  ds_read_b128 v[120:123], v6 offset:2112
  ds_read_b128 v[108:111], v6 offset:1632
  ds_read_b128 v[124:127], v6 offset:2144
  s_waitcnt lgkmcnt(0)
  v_pk_mul_f32 v[132:133], v[32:33], v[96:97]
  v_pk_mul_f32 v[134:135], v[34:35], v[98:99]
  v_pk_mul_f32 v[136:137], v[36:37], v[100:101]
  v_pk_mul_f32 v[138:139], v[38:39], v[102:103]
  v_pk_fma_f32 v[132:133], v[112:113], v[28:29], v[132:133] op_sel_hi:[1,0,1] neg_lo:[0,1,0] neg_hi:[0,1,0]
  v_pk_fma_f32 v[134:135], v[114:115], v[28:29], v[134:135] op_sel_hi:[1,0,1] neg_lo:[0,1,0] neg_hi:[0,1,0]
  v_pk_fma_f32 v[136:137], v[116:117], v[28:29], v[136:137] op_sel_hi:[1,0,1] neg_lo:[0,1,0] neg_hi:[0,1,0]
  v_pk_fma_f32 v[138:139], v[118:119], v[28:29], v[138:139] op_sel_hi:[1,0,1] neg_lo:[0,1,0] neg_hi:[0,1,0]
  v_cvt_pk_bf16_f32 v148, v132, v133
  v_cvt_pk_bf16_f32 v149, v134, v135
  v_cvt_pk_bf16_f32 v150, v136, v137
  v_cvt_pk_bf16_f32 v151, v138, v139
  v_lshlrev_b32 v132, 16, v148
  v_and_b32 v133, 0xffff0000, v148
  v_lshlrev_b32 v134, 16, v149
  v_and_b32 v135, 0xffff0000, v149
  v_lshlrev_b32 v136, 16, v150
  v_and_b32 v137, 0xffff0000, v150
  v_lshlrev_b32 v138, 16, v151
  v_and_b32 v139, 0xffff0000, v151
  v_min_f32 v140, 0, v132
  v_min_f32 v141, 0, v133
  v_min_f32 v142, 0, v134
  v_min_f32 v143, 0, v135
  v_min_f32 v144, 0, v136
  v_min_f32 v145, 0, v137
  v_min_f32 v146, 0, v138
  v_min_f32 v147, 0, v139
  v_pk_add_f32 v[132:133], v[132:133], v[140:141] neg_lo:[0,1] neg_hi:[0,1]
  v_pk_add_f32 v[134:135], v[134:135], v[142:143] neg_lo:[0,1] neg_hi:[0,1]
  v_pk_add_f32 v[136:137], v[136:137], v[144:145] neg_lo:[0,1] neg_hi:[0,1]
  v_pk_add_f32 v[138:139], v[138:139], v[146:147] neg_lo:[0,1] neg_hi:[0,1]
  v_pk_mul_f32 v[140:141], v[140:141], s[52:53]
  v_pk_mul_f32 v[142:143], v[142:143], s[52:53]
  v_pk_mul_f32 v[144:145], v[144:145], s[52:53]
  v_pk_mul_f32 v[146:147], v[146:147], s[52:53]
  v_exp_f32 v140, v140
  v_exp_f32 v141, v141
  v_exp_f32 v142, v142
  v_exp_f32 v143, v143
  v_exp_f32 v144, v144
  v_exp_f32 v145, v145
  v_exp_f32 v146, v146
  v_exp_f32 v147, v147
  v_pk_add_f32 v[132:133], v[132:133], s[56:57]
  v_pk_add_f32 v[134:135], v[134:135], s[56:57]
  v_pk_add_f32 v[136:137], v[136:137], s[56:57]
  v_pk_add_f32 v[138:139], v[138:139], s[56:57]
  v_pk_add_f32 v[132:133], v[132:133], v[140:141]
  v_pk_add_f32 v[134:135], v[134:135], v[142:143]
  v_pk_add_f32 v[136:137], v[136:137], v[144:145]
  v_pk_add_f32 v[138:139], v[138:139], v[146:147]
  v_cvt_pk_bf16_f32 v188, v132, v133
  v_cvt_pk_bf16_f32 v189, v134, v135
  v_cvt_pk_bf16_f32 v190, v136, v137
  v_cvt_pk_bf16_f32 v191, v138, v139
  v_pk_mul_f32 v[132:133], v[40:41], v[104:105]
  v_pk_mul_f32 v[134:135], v[42:43], v[106:107]
  v_pk_mul_f32 v[136:137], v[44:45], v[108:109]
  v_pk_mul_f32 v[138:139], v[46:47], v[110:111]
  v_pk_fma_f32 v[132:133], v[120:121], v[28:29], v[132:133] op_sel_hi:[1,0,1] neg_lo:[0,1,0] neg_hi:[0,1,0]
  v_pk_fma_f32 v[134:135], v[122:123], v[28:29], v[134:135] op_sel_hi:[1,0,1] neg_lo:[0,1,0] neg_hi:[0,1,0]
  v_pk_fma_f32 v[136:137], v[124:125], v[28:29], v[136:137] op_sel_hi:[1,0,1] neg_lo:[0,1,0] neg_hi:[0,1,0]
  v_pk_fma_f32 v[138:139], v[126:127], v[28:29], v[138:139] op_sel_hi:[1,0,1] neg_lo:[0,1,0] neg_hi:[0,1,0]
  v_cvt_pk_bf16_f32 v148, v132, v133
  v_cvt_pk_bf16_f32 v149, v134, v135
  v_cvt_pk_bf16_f32 v150, v136, v137
  v_cvt_pk_bf16_f32 v151, v138, v139
  v_lshlrev_b32 v132, 16, v148
  v_and_b32 v133, 0xffff0000, v148
  v_lshlrev_b32 v134, 16, v149
  v_and_b32 v135, 0xffff0000, v149
  v_lshlrev_b32 v136, 16, v150
  v_and_b32 v137, 0xffff0000, v150
  v_lshlrev_b32 v138, 16, v151
  v_and_b32 v139, 0xffff0000, v151
  v_min_f32 v140, 0, v132
  v_min_f32 v141, 0, v133
  v_min_f32 v142, 0, v134
  v_min_f32 v143, 0, v135
  v_min_f32 v144, 0, v136
  v_min_f32 v145, 0, v137
  v_min_f32 v146, 0, v138
  v_min_f32 v147, 0, v139
  v_pk_add_f32 v[132:133], v[132:133], v[140:141] neg_lo:[0,1] neg_hi:[0,1]
  v_pk_add_f32 v[134:135], v[134:135], v[142:143] neg_lo:[0,1] neg_hi:[0,1]
  v_pk_add_f32 v[136:137], v[136:137], v[144:145] neg_lo:[0,1] neg_hi:[0,1]
  v_pk_add_f32 v[138:139], v[138:139], v[146:147] neg_lo:[0,1] neg_hi:[0,1]
  v_pk_mul_f32 v[140:141], v[140:141], s[52:53]
  v_pk_mul_f32 v[142:143], v[142:143], s[52:53]
  v_pk_mul_f32 v[144:145], v[144:145], s[52:53]
  v_pk_mul_f32 v[146:147], v[146:147], s[52:53]
  v_exp_f32 v140, v140
  v_exp_f32 v141, v141
  v_exp_f32 v142, v142
  v_exp_f32 v143, v143
  v_exp_f32 v144, v144
  v_exp_f32 v145, v145
  v_exp_f32 v146, v146
  v_exp_f32 v147, v147
  v_pk_add_f32 v[132:133], v[132:133], s[56:57]
  v_pk_add_f32 v[134:135], v[134:135], s[56:57]
  v_pk_add_f32 v[136:137], v[136:137], s[56:57]
  v_pk_add_f32 v[138:139], v[138:139], s[56:57]
  v_pk_add_f32 v[132:133], v[132:133], v[140:141]
  v_pk_add_f32 v[134:135], v[134:135], v[142:143]
  v_pk_add_f32 v[136:137], v[136:137], v[144:145]
  v_pk_add_f32 v[138:139], v[138:139], v[146:147]
  v_cvt_pk_bf16_f32 v192, v132, v133
  v_cvt_pk_bf16_f32 v193, v134, v135
  v_cvt_pk_bf16_f32 v194, v136, v137
  v_cvt_pk_bf16_f32 v195, v138, v139
  v_pk_mul_f32 v[132:133], v[48:49], v[96:97]
  v_pk_mul_f32 v[134:135], v[50:51], v[98:99]
  v_pk_mul_f32 v[136:137], v[52:53], v[100:101]
  v_pk_mul_f32 v[138:139], v[54:55], v[102:103]
  v_pk_fma_f32 v[132:133], v[112:113], v[30:31], v[132:133] op_sel_hi:[1,0,1] neg_lo:[0,1,0] neg_hi:[0,1,0]
  v_pk_fma_f32 v[134:135], v[114:115], v[30:31], v[134:135] op_sel_hi:[1,0,1] neg_lo:[0,1,0] neg_hi:[0,1,0]
  v_pk_fma_f32 v[136:137], v[116:117], v[30:31], v[136:137] op_sel_hi:[1,0,1] neg_lo:[0,1,0] neg_hi:[0,1,0]
  v_pk_fma_f32 v[138:139], v[118:119], v[30:31], v[138:139] op_sel_hi:[1,0,1] neg_lo:[0,1,0] neg_hi:[0,1,0]
  v_cvt_pk_bf16_f32 v196, v132, v133
  v_cvt_pk_bf16_f32 v197, v134, v135
  v_cvt_pk_bf16_f32 v198, v136, v137
  v_cvt_pk_bf16_f32 v199, v138, v139
  v_pk_mul_f32 v[132:133], v[56:57], v[104:105]
  v_pk_mul_f32 v[134:135], v[58:59], v[106:107]
  v_pk_mul_f32 v[136:137], v[60:61], v[108:109]
  v_pk_mul_f32 v[138:139], v[62:63], v[110:111]
  v_pk_fma_f32 v[132:133], v[120:121], v[30:31], v[132:133] op_sel_hi:[1,0,1] neg_lo:[0,1,0] neg_hi:[0,1,0]
  v_pk_fma_f32 v[134:135], v[122:123], v[30:31], v[134:135] op_sel_hi:[1,0,1] neg_lo:[0,1,0] neg_hi:[0,1,0]
  v_pk_fma_f32 v[136:137], v[124:125], v[30:31], v[136:137] op_sel_hi:[1,0,1] neg_lo:[0,1,0] neg_hi:[0,1,0]
  v_pk_fma_f32 v[138:139], v[126:127], v[30:31], v[138:139] op_sel_hi:[1,0,1] neg_lo:[0,1,0] neg_hi:[0,1,0]
  v_cvt_pk_bf16_f32 v200, v132, v133
  v_cvt_pk_bf16_f32 v201, v134, v135
  v_cvt_pk_bf16_f32 v202, v136, v137
  v_cvt_pk_bf16_f32 v203, v138, v139
  v_mov_b32 v24, 0x3f803f80
  v_mov_b32 v25, 0x3f803f80
  v_mov_b32 v26, 0x3f803f80
  v_mov_b32 v27, 0x3f803f80
  s_nop 1
  v_mfma_f32_32x32x16_bf16 v[96:111], v[196:199], v[188:191], 0
  v_mfma_f32_32x32x16_bf16 v[96:111], v[200:203], v[192:195], v[96:111]
  v_mfma_f32_32x32x16_bf16 v[112:127], v[24:27], v[188:191], 0
  v_mfma_f32_32x32x16_bf16 v[112:127], v[24:27], v[192:195], v[112:127]
  v_and_b32 v3, 16, v1
  v_cmp_ne_u32 vcc, 0, v3
  v_lshlrev_b32 v2, 4, v1
  s_lshl_b32 s6, s37, 13
  v_add_u32 v2, s6, v2
  s_nop 15
  v_cndmask_b32 v96, v96, v104, vcc
  v_cndmask_b32 v97, v97, v105, vcc
  v_cndmask_b32 v98, v98, v106, vcc
  v_cndmask_b32 v99, v99, v107, vcc
  v_cndmask_b32 v100, v100, v108, vcc
  v_cndmask_b32 v101, v101, v109, vcc
  v_cndmask_b32 v102, v102, v110, vcc
  v_cndmask_b32 v103, v103, v111, vcc
  v_lshlrev_b32 v2, 4, v1
  s_mul_i32 s6, s3, 2560
  v_add_u32 v2, s6, v2
  v_lshlrev_b32 v6, 2, v1
  v_add_u32 v6, s6, v6
  ds_write_b128 v2, v[96:99] offset:36864
  ds_write_b128 v2, v[100:103] offset:37888
  ds_write_b32 v6, v112 offset:38912
  s_waitcnt lgkmcnt(0)
  s_barrier
  s_cmp_ge_u32 s3, 2
  s_cbranch_scc1 P1_KVDONE
  ds_read_b128 v[128:131], v2 offset:41984
  ds_read_b128 v[132:135], v2 offset:43008
  ds_read_b32 v136, v6 offset:44032
  ds_read_b128 v[140:143], v2 offset:47104
  ds_read_b128 v[144:147], v2 offset:48128
  ds_read_b32 v148, v6 offset:49152
  ds_read_b128 v[152:155], v2 offset:52224
  ds_read_b128 v[156:159], v2 offset:53248
  ds_read_b32 v160, v6 offset:54272
  v_bfe_u32 v2, v1, 4, 1
  s_lshl_b32 s6, s34, 2
  s_lshl_b32 s7, s5, 1
  s_add_u32 s6, s6, s7
  v_add_u32 v2, s6, v2
  s_movk_i32 s6, 1088
  v_mul_lo_u32 v2, v2, s6
  v_lshrrev_b32 v3, 5, v1
  v_lshl_add_u32 v2, v3, 8, v2
  v_and_b32 v3, 15, v1
  v_lshl_add_u32 v2, v3, 2, v2
  s_waitcnt lgkmcnt(0)
  v_add_f32 v96, v96, v128
  v_add_f32 v97, v97, v129
  v_add_f32 v98, v98, v130
  v_add_f32 v99, v99, v131
  v_add_f32 v100, v100, v132
  v_add_f32 v101, v101, v133
  v_add_f32 v102, v102, v134
  v_add_f32 v103, v103, v135
  v_add_f32 v112, v112, v136
  v_add_f32 v96, v96, v140
  v_add_f32 v97, v97, v141
  v_add_f32 v98, v98, v142
  v_add_f32 v99, v99, v143
  v_add_f32 v100, v100, v144
  v_add_f32 v101, v101, v145
  v_add_f32 v102, v102, v146
  v_add_f32 v103, v103, v147
  v_add_f32 v112, v112, v148
  v_add_f32 v96, v96, v152
  v_add_f32 v97, v97, v153
  v_add_f32 v98, v98, v154
  v_add_f32 v99, v99, v155
  v_add_f32 v100, v100, v156
  v_add_f32 v101, v101, v157
  v_add_f32 v102, v102, v158
  v_add_f32 v103, v103, v159
  v_add_f32 v112, v112, v160
P1_POLL:
  s_waitcnt vmcnt(0)
  v_readfirstlane_b32 s6, v23
  s_cmp_eq_u32 s6, 1
  s_cbranch_scc1 P1_POLLED
  buffer_load_dword v23, v7, s[24:27], 0 offen sc1
  s_branch P1_POLL
P1_POLLED:
  buffer_atomic_add_f32 v96, v2, s[20:23], 0 offen offset:0
  buffer_atomic_add_f32 v97, v2, s[20:23], 0 offen offset:64
  buffer_atomic_add_f32 v98, v2, s[20:23], 0 offen offset:128
  buffer_atomic_add_f32 v99, v2, s[20:23], 0 offen offset:192
  buffer_atomic_add_f32 v100, v2, s[20:23], 0 offen offset:512
  buffer_atomic_add_f32 v101, v2, s[20:23], 0 offen offset:576
  buffer_atomic_add_f32 v102, v2, s[20:23], 0 offen offset:640
  buffer_atomic_add_f32 v103, v2, s[20:23], 0 offen offset:704
  s_mov_b32 exec_hi, 0
  buffer_atomic_add_f32 v112, v2, s[20:23], 0 offen offset:1024
  s_mov_b64 exec, -1
P1_KVDONE:
  s_endpgm
P1_REPACK:
  s_cmp_ge_u32 s3, 4
  s_cbranch_scc0 P1_REPACK2
  s_load_dwordx2 s[42:43], s[0:1], 32
  s_sub_u32 s31, s2, 192
  s_lshl_b32 s31, s31, 2
  s_add_u32 s31, s31, s37
  s_lshl_b32 s31, s31, 14
  v_lshlrev_b32 v2, 7, v1
  s_waitcnt lgkmcnt(0)
  s_mov_b32 s8, s42
  s_mov_b32 s9, s43
  s_mov_b32 s10, 0x1c0000
  s_mov_b32 s11, 0x20000
  buffer_load_dword v3, v2, s[8:11], s31 offen
  s_add_u32 s31, s31, 8192
  buffer_load_dword v4, v2, s[8:11], s31 offen
  s_endpgm
P1_REPACK2:
  s_sub_u32 s31, s2, 192
  s_waitcnt lgkmcnt(0)
  s_cmp_lt_u32 s31, 28
  s_cbranch_scc0 P1_RP_WO
  s_mov_b32 s8, s46
  s_mov_b32 s9, s47
  s_mov_b32 s10, 0x1c0000
  s_mov_b32 s11, 0x20000
  s_add_u32 s16, s50, 0xb00000
  s_addc_u32 s17, s51, 0
  s_mov_b32 s18, 0x1c0000
  s_mov_b32 s19, 0x20000
  s_branch P1_RP_GO
P1_RP_WO:
  s_sub_u32 s31, s31, 28
  s_mov_b32 s8, s44
  s_mov_b32 s9, s45
  s_mov_b32 s10, 0x80000
  s_mov_b32 s11, 0x20000
  s_add_u32 s16, s50, 0xcc0000
  s_addc_u32 s17, s51, 0
  s_mov_b32 s18, 0x80000
  s_mov_b32 s19, 0x20000
P1_RP_GO:
  v_lshlrev_b32 v2, 4, v1
  s_lshl_b32 s6, s31, 16
  s_lshl_b32 s7, s3, 14
  s_add_u32 s6, s6, s7
  s_add_u32 m0, s7, 0
  s_add_u32 s28, s6, 0
  buffer_load_dwordx4 v2, s[8:11], s28 offen lds
  s_add_u32 m0, s7, 1024
  s_add_u32 s28, s6, 1024
  buffer_load_dwordx4 v2, s[8:11], s28 offen lds
  s_add_u32 m0, s7, 2048
  s_add_u32 s28, s6, 2048
  buffer_load_dwordx4 v2, s[8:11], s28 offen lds
  s_add_u32 m0, s7, 3072
  s_add_u32 s28, s6, 3072
  buffer_load_dwordx4 v2, s[8:11], s28 offen lds
  s_add_u32 m0, s7, 4096
  s_add_u32 s28, s6, 4096
  buffer_load_dwordx4 v2, s[8:11], s28 offen lds
  s_add_u32 m0, s7, 5120
  s_add_u32 s28, s6, 5120
  buffer_load_dwordx4 v2, s[8:11], s28 offen lds
  s_add_u32 m0, s7, 6144
  s_add_u32 s28, s6, 6144
  buffer_load_dwordx4 v2, s[8:11], s28 offen lds
  s_add_u32 m0, s7, 7168
  s_add_u32 s28, s6, 7168
  buffer_load_dwordx4 v2, s[8:11], s28 offen lds
  s_add_u32 m0, s7, 8192
  s_add_u32 s28, s6, 8192
  buffer_load_dwordx4 v2, s[8:11], s28 offen lds
  s_add_u32 m0, s7, 9216
  s_add_u32 s28, s6, 9216
  buffer_load_dwordx4 v2, s[8:11], s28 offen lds
  s_add_u32 m0, s7, 10240
  s_add_u32 s28, s6, 10240
  buffer_load_dwordx4 v2, s[8:11], s28 offen lds
  s_add_u32 m0, s7, 11264
  s_add_u32 s28, s6, 11264
  buffer_load_dwordx4 v2, s[8:11], s28 offen lds
  s_add_u32 m0, s7, 12288
  s_add_u32 s28, s6, 12288
  buffer_load_dwordx4 v2, s[8:11], s28 offen lds
  s_add_u32 m0, s7, 13312
  s_add_u32 s28, s6, 13312
  buffer_load_dwordx4 v2, s[8:11], s28 offen lds
  s_add_u32 m0, s7, 14336
  s_add_u32 s28, s6, 14336
  buffer_load_dwordx4 v2, s[8:11], s28 offen lds
  s_add_u32 m0, s7, 15360
  s_add_u32 s28, s6, 15360
  buffer_load_dwordx4 v2, s[8:11], s28 offen lds
  v_lshrrev_b32 v3, 5, v1
  v_lshlrev_b32 v3, 2, v3
  v_bfe_u32 v4, v1, 2, 2
  v_add_u32 v3, v3, v4
  v_lshlrev_b32 v3, 10, v3
  v_add_u32 v3, s7, v3
  v_bfe_u32 v4, v1, 4, 1
  v_lshl_add_u32 v3, v4, 5, v3
  v_and_b32 v4, 3, v1
  v_lshl_add_u32 v3, v4, 3, v3
  s_lshl_b32 s6, s31, 2
  s_add_u32 s6, s6, s3
  s_lshl_b32 s6, s6, 14
  s_waitcnt vmcnt(0)
  ds_read_b64_tr_b16 v[16:17], v3 offset:0
  ds_read_b64_tr_b16 v[18:19], v3 offset:8192
  s_waitcnt lgkmcnt(0)
  s_add_u32 s7, s6, 0
  buffer_store_dwordx4 v[16:19], v2, s[16:19], s7 offen
  ds_read_b64_tr_b16 v[20:21], v3 offset:64
  ds_read_b64_tr_b16 v[22:23], v3 offset:8256
  s_waitcnt lgkmcnt(0)
  s_add_u32 s7, s6, 1024
  buffer_store_dwordx4 v[20:23], v2, s[16:19], s7 offen
  ds_read_b64_tr_b16 v[24:25], v3 offset:128
  ds_read_b64_tr_b16 v[26:27], v3 offset:8320
  s_waitcnt lgkmcnt(0)
  s_add_u32 s7, s6, 2048
  buffer_store_dwordx4 v[24:27], v2, s[16:19], s7 offen
  ds_read_b64_tr_b16 v[28:29], v3 offset:192
  ds_read_b64_tr_b16 v[30:31], v3 offset:8384
  s_waitcnt lgkmcnt(0)
  s_add_u32 s7, s6, 3072
  buffer_store_dwordx4 v[28:31], v2, s[16:19], s7 offen
  ds_read_b64_tr_b16 v[16:17], v3 offset:256
  ds_read_b64_tr_b16 v[18:19], v3 offset:8448
  s_waitcnt lgkmcnt(0)
  s_add_u32 s7, s6, 4096
  buffer_store_dwordx4 v[16:19], v2, s[16:19], s7 offen
  ds_read_b64_tr_b16 v[20:21], v3 offset:320
  ds_read_b64_tr_b16 v[22:23], v3 offset:8512
  s_waitcnt lgkmcnt(0)
  s_add_u32 s7, s6, 5120
  buffer_store_dwordx4 v[20:23], v2, s[16:19], s7 offen
  ds_read_b64_tr_b16 v[24:25], v3 offset:384
  ds_read_b64_tr_b16 v[26:27], v3 offset:8576
  s_waitcnt lgkmcnt(0)
  s_add_u32 s7, s6, 6144
  buffer_store_dwordx4 v[24:27], v2, s[16:19], s7 offen
  ds_read_b64_tr_b16 v[28:29], v3 offset:448
  ds_read_b64_tr_b16 v[30:31], v3 offset:8640
  s_waitcnt lgkmcnt(0)
  s_add_u32 s7, s6, 7168
  buffer_store_dwordx4 v[28:31], v2, s[16:19], s7 offen
  ds_read_b64_tr_b16 v[16:17], v3 offset:512
  ds_read_b64_tr_b16 v[18:19], v3 offset:8704
  s_waitcnt lgkmcnt(0)
  s_add_u32 s7, s6, 8192
  buffer_store_dwordx4 v[16:19], v2, s[16:19], s7 offen
  ds_read_b64_tr_b16 v[20:21], v3 offset:576
  ds_read_b64_tr_b16 v[22:23], v3 offset:8768
  s_waitcnt lgkmcnt(0)
  s_add_u32 s7, s6, 9216
  buffer_store_dwordx4 v[20:23], v2, s[16:19], s7 offen
  ds_read_b64_tr_b16 v[24:25], v3 offset:640
  ds_read_b64_tr_b16 v[26:27], v3 offset:8832
  s_waitcnt lgkmcnt(0)
  s_add_u32 s7, s6, 10240
  buffer_store_dwordx4 v[24:27], v2, s[16:19], s7 offen
  ds_read_b64_tr_b16 v[28:29], v3 offset:704
  ds_read_b64_tr_b16 v[30:31], v3 offset:8896
  s_waitcnt lgkmcnt(0)
  s_add_u32 s7, s6, 11264
  buffer_store_dwordx4 v[28:31], v2, s[16:19], s7 offen
  ds_read_b64_tr_b16 v[16:17], v3 offset:768
  ds_read_b64_tr_b16 v[18:19], v3 offset:8960
  s_waitcnt lgkmcnt(0)
  s_add_u32 s7, s6, 12288
  buffer_store_dwordx4 v[16:19], v2, s[16:19], s7 offen
  ds_read_b64_tr_b16 v[20:21], v3 offset:832
  ds_read_b64_tr_b16 v[22:23], v3 offset:9024
  s_waitcnt lgkmcnt(0)
  s_add_u32 s7, s6, 13312
  buffer_store_dwordx4 v[20:23], v2, s[16:19], s7 offen
  ds_read_b64_tr_b16 v[24:25], v3 offset:896
  ds_read_b64_tr_b16 v[26:27], v3 offset:9088
  s_waitcnt lgkmcnt(0)
  s_add_u32 s7, s6, 14336
  buffer_store_dwordx4 v[24:27], v2, s[16:19], s7 offen
  ds_read_b64_tr_b16 v[28:29], v3 offset:960
  ds_read_b64_tr_b16 v[30:31], v3 offset:9152
  s_waitcnt lgkmcnt(0)
  s_add_u32 s7, s6, 15360
  buffer_store_dwordx4 v[28:31], v2, s[16:19], s7 offen
  s_endpgm
P1_END:
  s_endpgm
.globl p2_kernel
.p2align 8
.type p2_kernel,@function
p2_kernel:
  s_cmp_ge_u32 s2, 256
  s_cbranch_scc1 P2_END
  s_load_dwordx2 s[40:41], s[0:1], 0
  s_load_dwordx2 s[50:51], s[0:1], 64
  v_and_b32 v1, 63, v0
  v_lshrrev_b32 v2, 6, v0
  s_nop 0
  v_readfirstlane_b32 s3, v2
  s_and_b32 s6, s2, 7
  s_lshr_b32 s7, s2, 3
  s_and_b32 s4, s6, 3
  s_lshl_b32 s4, s4, 3
  s_and_b32 s5, s7, 7
  s_add_u32 s4, s4, s5
  s_lshr_b32 s5, s6, 2
  s_lshl_b32 s5, s5, 2
  s_lshr_b32 s7, s7, 3
  s_add_u32 s5, s5, s7
  v_lshlrev_b32 v2, 4, v1
  v_and_b32 v3, 31, v1
  v_lshlrev_b32 v4, 6, v3
  v_mov_b32 v5, 1024
  v_cmp_gt_u32 vcc, 16, v3
  s_nop 1
  v_cndmask_b32 v4, v5, v4, vcc
  v_lshrrev_b32 v5, 5, v1
  v_lshl_add_u32 v4, v5, 4, v4
  s_lshl_b32 s6, s4, 6
  s_lshr_b32 s7, s3, 1
  s_lshl_b32 s7, s7, 5
  s_add_u32 s6, s6, s7
  v_add_u32 v6, s6, v3
  v_lshlrev_b32 v6, 10, v6
  v_lshl_add_u32 v6, v5, 3, v6
  s_lshl_b32 s7, s5, 7
  s_and_b32 s8, s3, 1
  s_lshl_b32 s8, s8, 6
  s_add_u32 s7, s7, s8
  v_add_u32 v6, s7, v6
  s_waitcnt lgkmcnt(0)
  s_mov_b32 s8, s50
  s_mov_b32 s9, s51
  s_mov_b32 s10, 0x200000
  s_mov_b32 s11, 0x20000
  s_add_u32 s12, s50, 0xcc0000
  s_addc_u32 s13, s51, 0
  s_mov_b32 s14, 0x80000
  s_mov_b32 s15, 0x20000
  s_add_u32 s16, s50, 0xd40000
  s_addc_u32 s17, s51, 0
  s_mov_b32 s18, 0x8800
  s_mov_b32 s19, 0x20000
  s_mov_b32 s20, s40
  s_mov_b32 s21, s41
  s_mov_b32 s22, 0x200000
  s_mov_b32 s23, 0x20000
  s_add_u32 s24, s50, 0x200000
  s_addc_u32 s25, s51, 0
  s_mov_b32 s26, 0x200000
  s_mov_b32 s27, 0x20000
  s_add_u32 s28, s50, 0xd50000
  s_addc_u32 s29, s51, 0
  s_mov_b32 s30, 0x40000
  s_mov_b32 s31, 0x20000
  s_lshl_b32 s32, s4, 1
  s_lshl_b32 s32, s32, 5
  s_lshl_b32 s6, s3, 3
  s_add_u32 s32, s32, s6
  s_lshl_b32 s32, s32, 10
  s_lshl_b32 s33, s6, 4
  s_lshl_b32 s7, s5, 1
  s_add_u32 s33, s33, s7
  s_lshl_b32 s33, s33, 10
  s_mul_i32 s34, s6, 1088
  s_add_u32 s7, s34, 0
  buffer_load_dwordx4 v[32:35], v4, s[16:19], s7 offen
  buffer_load_dwordx4 v[36:39], v4, s[16:19], s7 offen offset:32
  s_add_u32 s7, s32, 0
  buffer_load_dwordx4 v[40:43], v2, s[8:11], s7 offen
  s_add_u32 s7, s32, 32768
  buffer_load_dwordx4 v[44:47], v2, s[8:11], s7 offen
  s_add_u32 s7, s33, 0
  buffer_load_dwordx4 v[48:51], v2, s[12:15], s7 offen offset:0
  buffer_load_dwordx4 v[52:55], v2, s[12:15], s7 offen offset:1024
  s_add_u32 s7, s34, 1088
  buffer_load_dwordx4 v[56:59], v4, s[16:19], s7 offen
  buffer_load_dwordx4 v[60:63], v4, s[16:19], s7 offen offset:32
  s_add_u32 s7, s32, 1024
  buffer_load_dwordx4 v[64:67], v2, s[8:11], s7 offen
  s_add_u32 s7, s32, 33792
  buffer_load_dwordx4 v[68:71], v2, s[8:11], s7 offen
  s_add_u32 s7, s33, 16384
  buffer_load_dwordx4 v[72:75], v2, s[12:15], s7 offen offset:0
  buffer_load_dwordx4 v[76:79], v2, s[12:15], s7 offen offset:1024
  s_add_u32 s7, s34, 2176
  buffer_load_dwordx4 v[80:83], v4, s[16:19], s7 offen
  buffer_load_dwordx4 v[84:87], v4, s[16:19], s7 offen offset:32
  s_add_u32 s7, s32, 2048
  buffer_load_dwordx4 v[88:91], v2, s[8:11], s7 offen
  s_add_u32 s7, s32, 34816
  buffer_load_dwordx4 v[92:95], v2, s[8:11], s7 offen
  s_add_u32 s7, s33, 32768
  buffer_load_dwordx4 v[96:99], v2, s[12:15], s7 offen offset:0
  buffer_load_dwordx4 v[100:103], v2, s[12:15], s7 offen offset:1024
  s_add_u32 s7, s34, 3264
  buffer_load_dwordx4 v[104:107], v4, s[16:19], s7 offen
  buffer_load_dwordx4 v[108:111], v4, s[16:19], s7 offen offset:32
  s_add_u32 s7, s32, 3072
  buffer_load_dwordx4 v[112:115], v2, s[8:11], s7 offen
  s_add_u32 s7, s32, 35840
  buffer_load_dwordx4 v[116:119], v2, s[8:11], s7 offen
  s_add_u32 s7, s33, 49152
  buffer_load_dwordx4 v[120:123], v2, s[12:15], s7 offen offset:0
  buffer_load_dwordx4 v[124:127], v2, s[12:15], s7 offen offset:1024
  s_waitcnt vmcnt(18)
  v_cvt_pk_bf16_f32 v8, v32, v33
  v_cvt_pk_bf16_f32 v9, v34, v35
  v_cvt_pk_bf16_f32 v10, v36, v37
  v_cvt_pk_bf16_f32 v11, v38, v39
  s_nop 1
  v_mfma_f32_32x32x16_bf16 v[152:167], v[8:11], v[40:43], 0
  v_mfma_f32_32x32x16_bf16 v[168:183], v[8:11], v[44:47], 0
  s_add_u32 s7, s34, 4352
  buffer_load_dwordx4 v[128:131], v4, s[16:19], s7 offen
  buffer_load_dwordx4 v[132:135], v4, s[16:19], s7 offen offset:32
  s_add_u32 s7, s32, 4096
  buffer_load_dwordx4 v[136:139], v2, s[8:11], s7 offen
  s_add_u32 s7, s32, 36864
  buffer_load_dwordx4 v[140:143], v2, s[8:11], s7 offen
  s_add_u32 s7, s33, 65536
  buffer_load_dwordx4 v[144:147], v2, s[12:15], s7 offen offset:0
  buffer_load_dwordx4 v[148:151], v2, s[12:15], s7 offen offset:1024
  s_waitcnt vmcnt(18)
  v_cvt_pk_bf16_f32 v12, v56, v57
  v_cvt_pk_bf16_f32 v13, v58, v59
  v_cvt_pk_bf16_f32 v14, v60, v61
  v_cvt_pk_bf16_f32 v15, v62, v63
  s_nop 1
  v_mfma_f32_32x32x16_bf16 v[184:199], v[12:15], v[64:67], 0
  v_mfma_f32_32x32x16_bf16 v[200:215], v[12:15], v[68:71], 0
  s_nop 7
  s_nop 7
  v_cvt_pk_bf16_f32 v16, v160, v160
  v_lshlrev_b32 v16, 16, v16
  v_cvt_pk_bf16_f32 v17, v176, v176
  v_lshlrev_b32 v17, 16, v17
  v_add_f32 v16, 0x358637bd, v16
  v_add_f32 v17, 0x358637bd, v17
  v_cvt_pk_bf16_f32 v16, v16, v16
  v_lshlrev_b32 v16, 16, v16
  v_cvt_pk_bf16_f32 v17, v17, v17
  v_lshlrev_b32 v17, 16, v17
  v_rcp_f32 v16, v16
  v_rcp_f32 v17, v17
  v_cvt_pk_bf16_f32 v18, v152, v153
  v_cvt_pk_bf16_f32 v19, v154, v155
  v_cvt_pk_bf16_f32 v20, v156, v157
  v_cvt_pk_bf16_f32 v21, v158, v159
  v_cvt_pk_bf16_f32 v22, v168, v169
  v_cvt_pk_bf16_f32 v23, v170, v171
  v_cvt_pk_bf16_f32 v24, v172, v173
  v_cvt_pk_bf16_f32 v25, v174, v175
  v_lshlrev_b32 v152, 16, v18
  v_and_b32 v153, 0xffff0000, v18
  v_lshlrev_b32 v154, 16, v19
  v_and_b32 v155, 0xffff0000, v19
  v_lshlrev_b32 v156, 16, v20
  v_and_b32 v157, 0xffff0000, v20
  v_lshlrev_b32 v158, 16, v21
  v_and_b32 v159, 0xffff0000, v21
  v_lshlrev_b32 v168, 16, v22
  v_and_b32 v169, 0xffff0000, v22
  v_lshlrev_b32 v170, 16, v23
  v_and_b32 v171, 0xffff0000, v23
  v_lshlrev_b32 v172, 16, v24
  v_and_b32 v173, 0xffff0000, v24
  v_lshlrev_b32 v174, 16, v25
  v_and_b32 v175, 0xffff0000, v25
  v_mul_f32 v152, v152, v16
  v_mul_f32 v153, v153, v16
  v_mul_f32 v154, v154, v16
  v_mul_f32 v155, v155, v16
  v_mul_f32 v156, v156, v16
  v_mul_f32 v157, v157, v16
  v_mul_f32 v158, v158, v16
  v_mul_f32 v159, v159, v16
  v_mul_f32 v168, v168, v17
  v_mul_f32 v169, v169, v17
  v_mul_f32 v170, v170, v17
  v_mul_f32 v171, v171, v17
  v_mul_f32 v172, v172, v17
  v_mul_f32 v173, v173, v17
  v_mul_f32 v174, v174, v17
  v_mul_f32 v175, v175, v17
  v_cvt_pk_bf16_f32 v216, v152, v153
  v_cvt_pk_bf16_f32 v217, v154, v155
  v_cvt_pk_bf16_f32 v218, v156, v157
  v_cvt_pk_bf16_f32 v219, v158, v159
  v_cvt_pk_bf16_f32 v220, v168, v169
  v_cvt_pk_bf16_f32 v221, v170, v171
  v_cvt_pk_bf16_f32 v222, v172, v173
  v_cvt_pk_bf16_f32 v223, v174, v175
  s_nop 1
  v_mfma_f32_32x32x16_bf16 a[0:15], v[48:51], v[216:219], 0
  v_mfma_f32_32x32x16_bf16 a[16:31], v[52:55], v[216:219], 0
  v_mfma_f32_32x32x16_bf16 a[32:47], v[48:51], v[220:223], 0
  v_mfma_f32_32x32x16_bf16 a[48:63], v[52:55], v[220:223], 0
  s_add_u32 s7, s34, 5440
  buffer_load_dwordx4 v[32:35], v4, s[16:19], s7 offen
  buffer_load_dwordx4 v[36:39], v4, s[16:19], s7 offen offset:32
  s_add_u32 s7, s32, 5120
  buffer_load_dwordx4 v[40:43], v2, s[8:11], s7 offen
  s_add_u32 s7, s32, 37888
  buffer_load_dwordx4 v[44:47], v2, s[8:11], s7 offen
  s_add_u32 s7, s33, 81920
  buffer_load_dwordx4 v[48:51], v2, s[12:15], s7 offen offset:0
  buffer_load_dwordx4 v[52:55], v2, s[12:15], s7 offen offset:1024
  s_waitcnt vmcnt(18)
  v_cvt_pk_bf16_f32 v8, v80, v81
  v_cvt_pk_bf16_f32 v9, v82, v83
  v_cvt_pk_bf16_f32 v10, v84, v85
  v_cvt_pk_bf16_f32 v11, v86, v87
  s_nop 1
  v_mfma_f32_32x32x16_bf16 v[152:167], v[8:11], v[88:91], 0
  v_mfma_f32_32x32x16_bf16 v[168:183], v[8:11], v[92:95], 0
  s_nop 7
  s_nop 7
  v_cvt_pk_bf16_f32 v16, v192, v192
  v_lshlrev_b32 v16, 16, v16
  v_cvt_pk_bf16_f32 v17, v208, v208
  v_lshlrev_b32 v17, 16, v17
  v_add_f32 v16, 0x358637bd, v16
  v_add_f32 v17, 0x358637bd, v17
  v_cvt_pk_bf16_f32 v16, v16, v16
  v_lshlrev_b32 v16, 16, v16
  v_cvt_pk_bf16_f32 v17, v17, v17
  v_lshlrev_b32 v17, 16, v17
  v_rcp_f32 v16, v16
  v_rcp_f32 v17, v17
  v_cvt_pk_bf16_f32 v18, v184, v185
  v_cvt_pk_bf16_f32 v19, v186, v187
  v_cvt_pk_bf16_f32 v20, v188, v189
  v_cvt_pk_bf16_f32 v21, v190, v191
  v_cvt_pk_bf16_f32 v22, v200, v201
  v_cvt_pk_bf16_f32 v23, v202, v203
  v_cvt_pk_bf16_f32 v24, v204, v205
  v_cvt_pk_bf16_f32 v25, v206, v207
  v_lshlrev_b32 v184, 16, v18
  v_and_b32 v185, 0xffff0000, v18
  v_lshlrev_b32 v186, 16, v19
  v_and_b32 v187, 0xffff0000, v19
  v_lshlrev_b32 v188, 16, v20
  v_and_b32 v189, 0xffff0000, v20
  v_lshlrev_b32 v190, 16, v21
  v_and_b32 v191, 0xffff0000, v21
  v_lshlrev_b32 v200, 16, v22
  v_and_b32 v201, 0xffff0000, v22
  v_lshlrev_b32 v202, 16, v23
  v_and_b32 v203, 0xffff0000, v23
  v_lshlrev_b32 v204, 16, v24
  v_and_b32 v205, 0xffff0000, v24
  v_lshlrev_b32 v206, 16, v25
  v_and_b32 v207, 0xffff0000, v25
  v_mul_f32 v184, v184, v16
  v_mul_f32 v185, v185, v16
  v_mul_f32 v186, v186, v16
  v_mul_f32 v187, v187, v16
  v_mul_f32 v188, v188, v16
  v_mul_f32 v189, v189, v16
  v_mul_f32 v190, v190, v16
  v_mul_f32 v191, v191, v16
  v_mul_f32 v200, v200, v17
  v_mul_f32 v201, v201, v17
  v_mul_f32 v202, v202, v17
  v_mul_f32 v203, v203, v17
  v_mul_f32 v204, v204, v17
  v_mul_f32 v205, v205, v17
  v_mul_f32 v206, v206, v17
  v_mul_f32 v207, v207, v17
  v_cvt_pk_bf16_f32 v216, v184, v185
  v_cvt_pk_bf16_f32 v217, v186, v187
  v_cvt_pk_bf16_f32 v218, v188, v189
  v_cvt_pk_bf16_f32 v219, v190, v191
  v_cvt_pk_bf16_f32 v220, v200, v201
  v_cvt_pk_bf16_f32 v221, v202, v203
  v_cvt_pk_bf16_f32 v222, v204, v205
  v_cvt_pk_bf16_f32 v223, v206, v207
  s_nop 1
  v_mfma_f32_32x32x16_bf16 a[0:15], v[72:75], v[216:219], a[0:15]
  v_mfma_f32_32x32x16_bf16 a[16:31], v[76:79], v[216:219], a[16:31]
  v_mfma_f32_32x32x16_bf16 a[32:47], v[72:75], v[220:223], a[32:47]
  v_mfma_f32_32x32x16_bf16 a[48:63], v[76:79], v[220:223], a[48:63]
  s_add_u32 s7, s34, 6528
  buffer_load_dwordx4 v[56:59], v4, s[16:19], s7 offen
  buffer_load_dwordx4 v[60:63], v4, s[16:19], s7 offen offset:32
  s_add_u32 s7, s32, 6144
  buffer_load_dwordx4 v[64:67], v2, s[8:11], s7 offen
  s_add_u32 s7, s32, 38912
  buffer_load_dwordx4 v[68:71], v2, s[8:11], s7 offen
  s_add_u32 s7, s33, 98304
  buffer_load_dwordx4 v[72:75], v2, s[12:15], s7 offen offset:0
  buffer_load_dwordx4 v[76:79], v2, s[12:15], s7 offen offset:1024
  s_waitcnt vmcnt(18)
  v_cvt_pk_bf16_f32 v12, v104, v105
  v_cvt_pk_bf16_f32 v13, v106, v107
  v_cvt_pk_bf16_f32 v14, v108, v109
  v_cvt_pk_bf16_f32 v15, v110, v111
  s_nop 1
  v_mfma_f32_32x32x16_bf16 v[184:199], v[12:15], v[112:115], 0
  v_mfma_f32_32x32x16_bf16 v[200:215], v[12:15], v[116:119], 0
  s_nop 7
  s_nop 7
  v_cvt_pk_bf16_f32 v16, v160, v160
  v_lshlrev_b32 v16, 16, v16
  v_cvt_pk_bf16_f32 v17, v176, v176
  v_lshlrev_b32 v17, 16, v17
  v_add_f32 v16, 0x358637bd, v16
  v_add_f32 v17, 0x358637bd, v17
  v_cvt_pk_bf16_f32 v16, v16, v16
  v_lshlrev_b32 v16, 16, v16
  v_cvt_pk_bf16_f32 v17, v17, v17
  v_lshlrev_b32 v17, 16, v17
  v_rcp_f32 v16, v16
  v_rcp_f32 v17, v17
  v_cvt_pk_bf16_f32 v18, v152, v153
  v_cvt_pk_bf16_f32 v19, v154, v155
  v_cvt_pk_bf16_f32 v20, v156, v157
  v_cvt_pk_bf16_f32 v21, v158, v159
  v_cvt_pk_bf16_f32 v22, v168, v169
  v_cvt_pk_bf16_f32 v23, v170, v171
  v_cvt_pk_bf16_f32 v24, v172, v173
  v_cvt_pk_bf16_f32 v25, v174, v175
  v_lshlrev_b32 v152, 16, v18
  v_and_b32 v153, 0xffff0000, v18
  v_lshlrev_b32 v154, 16, v19
  v_and_b32 v155, 0xffff0000, v19
  v_lshlrev_b32 v156, 16, v20
  v_and_b32 v157, 0xffff0000, v20
  v_lshlrev_b32 v158, 16, v21
  v_and_b32 v159, 0xffff0000, v21
  v_lshlrev_b32 v168, 16, v22
  v_and_b32 v169, 0xffff0000, v22
  v_lshlrev_b32 v170, 16, v23
  v_and_b32 v171, 0xffff0000, v23
  v_lshlrev_b32 v172, 16, v24
  v_and_b32 v173, 0xffff0000, v24
  v_lshlrev_b32 v174, 16, v25
  v_and_b32 v175, 0xffff0000, v25
  v_mul_f32 v152, v152, v16
  v_mul_f32 v153, v153, v16
  v_mul_f32 v154, v154, v16
  v_mul_f32 v155, v155, v16
  v_mul_f32 v156, v156, v16
  v_mul_f32 v157, v157, v16
  v_mul_f32 v158, v158, v16
  v_mul_f32 v159, v159, v16
  v_mul_f32 v168, v168, v17
  v_mul_f32 v169, v169, v17
  v_mul_f32 v170, v170, v17
  v_mul_f32 v171, v171, v17
  v_mul_f32 v172, v172, v17
  v_mul_f32 v173, v173, v17
  v_mul_f32 v174, v174, v17
  v_mul_f32 v175, v175, v17
  v_cvt_pk_bf16_f32 v216, v152, v153
  v_cvt_pk_bf16_f32 v217, v154, v155
  v_cvt_pk_bf16_f32 v218, v156, v157
  v_cvt_pk_bf16_f32 v219, v158, v159
  v_cvt_pk_bf16_f32 v220, v168, v169
  v_cvt_pk_bf16_f32 v221, v170, v171
  v_cvt_pk_bf16_f32 v222, v172, v173
  v_cvt_pk_bf16_f32 v223, v174, v175
  s_nop 1
  v_mfma_f32_32x32x16_bf16 a[0:15], v[96:99], v[216:219], a[0:15]
  v_mfma_f32_32x32x16_bf16 a[16:31], v[100:103], v[216:219], a[16:31]
  v_mfma_f32_32x32x16_bf16 a[32:47], v[96:99], v[220:223], a[32:47]
  v_mfma_f32_32x32x16_bf16 a[48:63], v[100:103], v[220:223], a[48:63]
  s_add_u32 s7, s34, 7616
  buffer_load_dwordx4 v[80:83], v4, s[16:19], s7 offen
  buffer_load_dwordx4 v[84:87], v4, s[16:19], s7 offen offset:32
  s_add_u32 s7, s32, 7168
  buffer_load_dwordx4 v[88:91], v2, s[8:11], s7 offen
  s_add_u32 s7, s32, 39936
  buffer_load_dwordx4 v[92:95], v2, s[8:11], s7 offen
  s_add_u32 s7, s33, 114688
  buffer_load_dwordx4 v[96:99], v2, s[12:15], s7 offen offset:0
  buffer_load_dwordx4 v[100:103], v2, s[12:15], s7 offen offset:1024
  s_waitcnt vmcnt(18)
  v_cvt_pk_bf16_f32 v8, v128, v129
  v_cvt_pk_bf16_f32 v9, v130, v131
  v_cvt_pk_bf16_f32 v10, v132, v133
  v_cvt_pk_bf16_f32 v11, v134, v135
  s_nop 1
  v_mfma_f32_32x32x16_bf16 v[152:167], v[8:11], v[136:139], 0
  v_mfma_f32_32x32x16_bf16 v[168:183], v[8:11], v[140:143], 0
  s_nop 7
  s_nop 7
  v_cvt_pk_bf16_f32 v16, v192, v192
  v_lshlrev_b32 v16, 16, v16
  v_cvt_pk_bf16_f32 v17, v208, v208
  v_lshlrev_b32 v17, 16, v17
  v_add_f32 v16, 0x358637bd, v16
  v_add_f32 v17, 0x358637bd, v17
  v_cvt_pk_bf16_f32 v16, v16, v16
  v_lshlrev_b32 v16, 16, v16
  v_cvt_pk_bf16_f32 v17, v17, v17
  v_lshlrev_b32 v17, 16, v17
  v_rcp_f32 v16, v16
  v_rcp_f32 v17, v17
  v_cvt_pk_bf16_f32 v18, v184, v185
  v_cvt_pk_bf16_f32 v19, v186, v187
  v_cvt_pk_bf16_f32 v20, v188, v189
  v_cvt_pk_bf16_f32 v21, v190, v191
  v_cvt_pk_bf16_f32 v22, v200, v201
  v_cvt_pk_bf16_f32 v23, v202, v203
  v_cvt_pk_bf16_f32 v24, v204, v205
  v_cvt_pk_bf16_f32 v25, v206, v207
  v_lshlrev_b32 v184, 16, v18
  v_and_b32 v185, 0xffff0000, v18
  v_lshlrev_b32 v186, 16, v19
  v_and_b32 v187, 0xffff0000, v19
  v_lshlrev_b32 v188, 16, v20
  v_and_b32 v189, 0xffff0000, v20
  v_lshlrev_b32 v190, 16, v21
  v_and_b32 v191, 0xffff0000, v21
  v_lshlrev_b32 v200, 16, v22
  v_and_b32 v201, 0xffff0000, v22
  v_lshlrev_b32 v202, 16, v23
  v_and_b32 v203, 0xffff0000, v23
  v_lshlrev_b32 v204, 16, v24
  v_and_b32 v205, 0xffff0000, v24
  v_lshlrev_b32 v206, 16, v25
  v_and_b32 v207, 0xffff0000, v25
  v_mul_f32 v184, v184, v16
  v_mul_f32 v185, v185, v16
  v_mul_f32 v186, v186, v16
  v_mul_f32 v187, v187, v16
  v_mul_f32 v188, v188, v16
  v_mul_f32 v189, v189, v16
  v_mul_f32 v190, v190, v16
  v_mul_f32 v191, v191, v16
  v_mul_f32 v200, v200, v17
  v_mul_f32 v201, v201, v17
  v_mul_f32 v202, v202, v17
  v_mul_f32 v203, v203, v17
  v_mul_f32 v204, v204, v17
  v_mul_f32 v205, v205, v17
  v_mul_f32 v206, v206, v17
  v_mul_f32 v207, v207, v17
  v_cvt_pk_bf16_f32 v216, v184, v185
  v_cvt_pk_bf16_f32 v217, v186, v187
  v_cvt_pk_bf16_f32 v218, v188, v189
  v_cvt_pk_bf16_f32 v219, v190, v191
  v_cvt_pk_bf16_f32 v220, v200, v201
  v_cvt_pk_bf16_f32 v221, v202, v203
  v_cvt_pk_bf16_f32 v222, v204, v205
  v_cvt_pk_bf16_f32 v223, v206, v207
  s_nop 1
  v_mfma_f32_32x32x16_bf16 a[0:15], v[120:123], v[216:219], a[0:15]
  v_mfma_f32_32x32x16_bf16 a[16:31], v[124:127], v[216:219], a[16:31]
  v_mfma_f32_32x32x16_bf16 a[32:47], v[120:123], v[220:223], a[32:47]
  v_mfma_f32_32x32x16_bf16 a[48:63], v[124:127], v[220:223], a[48:63]
  buffer_load_dwordx2 v[224:225], v6, s[20:23], 0 offen offset:0
  buffer_load_dwordx2 v[226:227], v6, s[20:23], 0 offen offset:16
  buffer_load_dwordx2 v[228:229], v6, s[20:23], 0 offen offset:32
  buffer_load_dwordx2 v[230:231], v6, s[20:23], 0 offen offset:48
  s_waitcnt vmcnt(16)
  v_cvt_pk_bf16_f32 v12, v32, v33
  v_cvt_pk_bf16_f32 v13, v34, v35
  v_cvt_pk_bf16_f32 v14, v36, v37
  v_cvt_pk_bf16_f32 v15, v38, v39
  s_nop 1
  v_mfma_f32_32x32x16_bf16 v[184:199], v[12:15], v[40:43], 0
  v_mfma_f32_32x32x16_bf16 v[200:215], v[12:15], v[44:47], 0
  s_nop 7
  s_nop 7
  v_cvt_pk_bf16_f32 v16, v160, v160
  v_lshlrev_b32 v16, 16, v16
  v_cvt_pk_bf16_f32 v17, v176, v176
  v_lshlrev_b32 v17, 16, v17
  v_add_f32 v16, 0x358637bd, v16
  v_add_f32 v17, 0x358637bd, v17
  v_cvt_pk_bf16_f32 v16, v16, v16
  v_lshlrev_b32 v16, 16, v16
  v_cvt_pk_bf16_f32 v17, v17, v17
  v_lshlrev_b32 v17, 16, v17
  v_rcp_f32 v16, v16
  v_rcp_f32 v17, v17
  v_cvt_pk_bf16_f32 v18, v152, v153
  v_cvt_pk_bf16_f32 v19, v154, v155
  v_cvt_pk_bf16_f32 v20, v156, v157
  v_cvt_pk_bf16_f32 v21, v158, v159
  v_cvt_pk_bf16_f32 v22, v168, v169
  v_cvt_pk_bf16_f32 v23, v170, v171
  v_cvt_pk_bf16_f32 v24, v172, v173
  v_cvt_pk_bf16_f32 v25, v174, v175
  v_lshlrev_b32 v152, 16, v18
  v_and_b32 v153, 0xffff0000, v18
  v_lshlrev_b32 v154, 16, v19
  v_and_b32 v155, 0xffff0000, v19
  v_lshlrev_b32 v156, 16, v20
  v_and_b32 v157, 0xffff0000, v20
  v_lshlrev_b32 v158, 16, v21
  v_and_b32 v159, 0xffff0000, v21
  v_lshlrev_b32 v168, 16, v22
  v_and_b32 v169, 0xffff0000, v22
  v_lshlrev_b32 v170, 16, v23
  v_and_b32 v171, 0xffff0000, v23
  v_lshlrev_b32 v172, 16, v24
  v_and_b32 v173, 0xffff0000, v24
  v_lshlrev_b32 v174, 16, v25
  v_and_b32 v175, 0xffff0000, v25
  v_mul_f32 v152, v152, v16
  v_mul_f32 v153, v153, v16
  v_mul_f32 v154, v154, v16
  v_mul_f32 v155, v155, v16
  v_mul_f32 v156, v156, v16
  v_mul_f32 v157, v157, v16
  v_mul_f32 v158, v158, v16
  v_mul_f32 v159, v159, v16
  v_mul_f32 v168, v168, v17
  v_mul_f32 v169, v169, v17
  v_mul_f32 v170, v170, v17
  v_mul_f32 v171, v171, v17
  v_mul_f32 v172, v172, v17
  v_mul_f32 v173, v173, v17
  v_mul_f32 v174, v174, v17
  v_mul_f32 v175, v175, v17
  v_cvt_pk_bf16_f32 v216, v152, v153
  v_cvt_pk_bf16_f32 v217, v154, v155
  v_cvt_pk_bf16_f32 v218, v156, v157
  v_cvt_pk_bf16_f32 v219, v158, v159
  v_cvt_pk_bf16_f32 v220, v168, v169
  v_cvt_pk_bf16_f32 v221, v170, v171
  v_cvt_pk_bf16_f32 v222, v172, v173
  v_cvt_pk_bf16_f32 v223, v174, v175
  s_nop 1
  v_mfma_f32_32x32x16_bf16 a[0:15], v[144:147], v[216:219], a[0:15]
  v_mfma_f32_32x32x16_bf16 a[16:31], v[148:151], v[216:219], a[16:31]
  v_mfma_f32_32x32x16_bf16 a[32:47], v[144:147], v[220:223], a[32:47]
  v_mfma_f32_32x32x16_bf16 a[48:63], v[148:151], v[220:223], a[48:63]
  s_waitcnt vmcnt(10)
  v_cvt_pk_bf16_f32 v8, v56, v57
  v_cvt_pk_bf16_f32 v9, v58, v59
  v_cvt_pk_bf16_f32 v10, v60, v61
  v_cvt_pk_bf16_f32 v11, v62, v63
  s_nop 1
  v_mfma_f32_32x32x16_bf16 v[152:167], v[8:11], v[64:67], 0
  v_mfma_f32_32x32x16_bf16 v[168:183], v[8:11], v[68:71], 0
  s_nop 7
  s_nop 7
  v_cvt_pk_bf16_f32 v16, v192, v192
  v_lshlrev_b32 v16, 16, v16
  v_cvt_pk_bf16_f32 v17, v208, v208
  v_lshlrev_b32 v17, 16, v17
  v_add_f32 v16, 0x358637bd, v16
  v_add_f32 v17, 0x358637bd, v17
  v_cvt_pk_bf16_f32 v16, v16, v16
  v_lshlrev_b32 v16, 16, v16
  v_cvt_pk_bf16_f32 v17, v17, v17
  v_lshlrev_b32 v17, 16, v17
  v_rcp_f32 v16, v16
  v_rcp_f32 v17, v17
  v_cvt_pk_bf16_f32 v18, v184, v185
  v_cvt_pk_bf16_f32 v19, v186, v187
  v_cvt_pk_bf16_f32 v20, v188, v189
  v_cvt_pk_bf16_f32 v21, v190, v191
  v_cvt_pk_bf16_f32 v22, v200, v201
  v_cvt_pk_bf16_f32 v23, v202, v203
  v_cvt_pk_bf16_f32 v24, v204, v205
  v_cvt_pk_bf16_f32 v25, v206, v207
  v_lshlrev_b32 v184, 16, v18
  v_and_b32 v185, 0xffff0000, v18
  v_lshlrev_b32 v186, 16, v19
  v_and_b32 v187, 0xffff0000, v19
  v_lshlrev_b32 v188, 16, v20
  v_and_b32 v189, 0xffff0000, v20
  v_lshlrev_b32 v190, 16, v21
  v_and_b32 v191, 0xffff0000, v21
  v_lshlrev_b32 v200, 16, v22
  v_and_b32 v201, 0xffff0000, v22
  v_lshlrev_b32 v202, 16, v23
  v_and_b32 v203, 0xffff0000, v23
  v_lshlrev_b32 v204, 16, v24
  v_and_b32 v205, 0xffff0000, v24
  v_lshlrev_b32 v206, 16, v25
  v_and_b32 v207, 0xffff0000, v25
  v_mul_f32 v184, v184, v16
  v_mul_f32 v185, v185, v16
  v_mul_f32 v186, v186, v16
  v_mul_f32 v187, v187, v16
  v_mul_f32 v188, v188, v16
  v_mul_f32 v189, v189, v16
  v_mul_f32 v190, v190, v16
  v_mul_f32 v191, v191, v16
  v_mul_f32 v200, v200, v17
  v_mul_f32 v201, v201, v17
  v_mul_f32 v202, v202, v17
  v_mul_f32 v203, v203, v17
  v_mul_f32 v204, v204, v17
  v_mul_f32 v205, v205, v17
  v_mul_f32 v206, v206, v17
  v_mul_f32 v207, v207, v17
  v_cvt_pk_bf16_f32 v216, v184, v185
  v_cvt_pk_bf16_f32 v217, v186, v187
  v_cvt_pk_bf16_f32 v218, v188, v189
  v_cvt_pk_bf16_f32 v219, v190, v191
  v_cvt_pk_bf16_f32 v220, v200, v201
  v_cvt_pk_bf16_f32 v221, v202, v203
  v_cvt_pk_bf16_f32 v222, v204, v205
  v_cvt_pk_bf16_f32 v223, v206, v207
  s_nop 1
  v_mfma_f32_32x32x16_bf16 a[0:15], v[48:51], v[216:219], a[0:15]
  v_mfma_f32_32x32x16_bf16 a[16:31], v[52:55], v[216:219], a[16:31]
  v_mfma_f32_32x32x16_bf16 a[32:47], v[48:51], v[220:223], a[32:47]
  v_mfma_f32_32x32x16_bf16 a[48:63], v[52:55], v[220:223], a[48:63]
  s_waitcnt vmcnt(4)
  v_cvt_pk_bf16_f32 v12, v80, v81
  v_cvt_pk_bf16_f32 v13, v82, v83
  v_cvt_pk_bf16_f32 v14, v84, v85
  v_cvt_pk_bf16_f32 v15, v86, v87
  s_nop 1
  v_mfma_f32_32x32x16_bf16 v[184:199], v[12:15], v[88:91], 0
  v_mfma_f32_32x32x16_bf16 v[200:215], v[12:15], v[92:95], 0
  s_nop 7
  s_nop 7
  v_cvt_pk_bf16_f32 v16, v160, v160
  v_lshlrev_b32 v16, 16, v16
  v_cvt_pk_bf16_f32 v17, v176, v176
  v_lshlrev_b32 v17, 16, v17
  v_add_f32 v16, 0x358637bd, v16
  v_add_f32 v17, 0x358637bd, v17
  v_cvt_pk_bf16_f32 v16, v16, v16
  v_lshlrev_b32 v16, 16, v16
  v_cvt_pk_bf16_f32 v17, v17, v17
  v_lshlrev_b32 v17, 16, v17
  v_rcp_f32 v16, v16
  v_rcp_f32 v17, v17
  v_cvt_pk_bf16_f32 v18, v152, v153
  v_cvt_pk_bf16_f32 v19, v154, v155
  v_cvt_pk_bf16_f32 v20, v156, v157
  v_cvt_pk_bf16_f32 v21, v158, v159
  v_cvt_pk_bf16_f32 v22, v168, v169
  v_cvt_pk_bf16_f32 v23, v170, v171
  v_cvt_pk_bf16_f32 v24, v172, v173
  v_cvt_pk_bf16_f32 v25, v174, v175
  v_lshlrev_b32 v152, 16, v18
  v_and_b32 v153, 0xffff0000, v18
  v_lshlrev_b32 v154, 16, v19
  v_and_b32 v155, 0xffff0000, v19
  v_lshlrev_b32 v156, 16, v20
  v_and_b32 v157, 0xffff0000, v20
  v_lshlrev_b32 v158, 16, v21
  v_and_b32 v159, 0xffff0000, v21
  v_lshlrev_b32 v168, 16, v22
  v_and_b32 v169, 0xffff0000, v22
  v_lshlrev_b32 v170, 16, v23
  v_and_b32 v171, 0xffff0000, v23
  v_lshlrev_b32 v172, 16, v24
  v_and_b32 v173, 0xffff0000, v24
  v_lshlrev_b32 v174, 16, v25
  v_and_b32 v175, 0xffff0000, v25
  v_mul_f32 v152, v152, v16
  v_mul_f32 v153, v153, v16
  v_mul_f32 v154, v154, v16
  v_mul_f32 v155, v155, v16
  v_mul_f32 v156, v156, v16
  v_mul_f32 v157, v157, v16
  v_mul_f32 v158, v158, v16
  v_mul_f32 v159, v159, v16
  v_mul_f32 v168, v168, v17
  v_mul_f32 v169, v169, v17
  v_mul_f32 v170, v170, v17
  v_mul_f32 v171, v171, v17
  v_mul_f32 v172, v172, v17
  v_mul_f32 v173, v173, v17
  v_mul_f32 v174, v174, v17
  v_mul_f32 v175, v175, v17
  v_cvt_pk_bf16_f32 v216, v152, v153
  v_cvt_pk_bf16_f32 v217, v154, v155
  v_cvt_pk_bf16_f32 v218, v156, v157
  v_cvt_pk_bf16_f32 v219, v158, v159
  v_cvt_pk_bf16_f32 v220, v168, v169
  v_cvt_pk_bf16_f32 v221, v170, v171
  v_cvt_pk_bf16_f32 v222, v172, v173
  v_cvt_pk_bf16_f32 v223, v174, v175
  s_nop 1
  v_mfma_f32_32x32x16_bf16 a[0:15], v[72:75], v[216:219], a[0:15]
  v_mfma_f32_32x32x16_bf16 a[16:31], v[76:79], v[216:219], a[16:31]
  v_mfma_f32_32x32x16_bf16 a[32:47], v[72:75], v[220:223], a[32:47]
  v_mfma_f32_32x32x16_bf16 a[48:63], v[76:79], v[220:223], a[48:63]
  s_nop 7
  s_nop 7
  v_cvt_pk_bf16_f32 v16, v192, v192
  v_lshlrev_b32 v16, 16, v16
  v_cvt_pk_bf16_f32 v17, v208, v208
  v_lshlrev_b32 v17, 16, v17
  v_add_f32 v16, 0x358637bd, v16
  v_add_f32 v17, 0x358637bd, v17
  v_cvt_pk_bf16_f32 v16, v16, v16
  v_lshlrev_b32 v16, 16, v16
  v_cvt_pk_bf16_f32 v17, v17, v17
  v_lshlrev_b32 v17, 16, v17
  v_rcp_f32 v16, v16
  v_rcp_f32 v17, v17
  v_cvt_pk_bf16_f32 v18, v184, v185
  v_cvt_pk_bf16_f32 v19, v186, v187
  v_cvt_pk_bf16_f32 v20, v188, v189
  v_cvt_pk_bf16_f32 v21, v190, v191
  v_cvt_pk_bf16_f32 v22, v200, v201
  v_cvt_pk_bf16_f32 v23, v202, v203
  v_cvt_pk_bf16_f32 v24, v204, v205
  v_cvt_pk_bf16_f32 v25, v206, v207
  v_lshlrev_b32 v184, 16, v18
  v_and_b32 v185, 0xffff0000, v18
  v_lshlrev_b32 v186, 16, v19
  v_and_b32 v187, 0xffff0000, v19
  v_lshlrev_b32 v188, 16, v20
  v_and_b32 v189, 0xffff0000, v20
  v_lshlrev_b32 v190, 16, v21
  v_and_b32 v191, 0xffff0000, v21
  v_lshlrev_b32 v200, 16, v22
  v_and_b32 v201, 0xffff0000, v22
  v_lshlrev_b32 v202, 16, v23
  v_and_b32 v203, 0xffff0000, v23
  v_lshlrev_b32 v204, 16, v24
  v_and_b32 v205, 0xffff0000, v24
  v_lshlrev_b32 v206, 16, v25
  v_and_b32 v207, 0xffff0000, v25
  v_mul_f32 v184, v184, v16
  v_mul_f32 v185, v185, v16
  v_mul_f32 v186, v186, v16
  v_mul_f32 v187, v187, v16
  v_mul_f32 v188, v188, v16
  v_mul_f32 v189, v189, v16
  v_mul_f32 v190, v190, v16
  v_mul_f32 v191, v191, v16
  v_mul_f32 v200, v200, v17
  v_mul_f32 v201, v201, v17
  v_mul_f32 v202, v202, v17
  v_mul_f32 v203, v203, v17
  v_mul_f32 v204, v204, v17
  v_mul_f32 v205, v205, v17
  v_mul_f32 v206, v206, v17
  v_mul_f32 v207, v207, v17
  v_cvt_pk_bf16_f32 v216, v184, v185
  v_cvt_pk_bf16_f32 v217, v186, v187
  v_cvt_pk_bf16_f32 v218, v188, v189
  v_cvt_pk_bf16_f32 v219, v190, v191
  v_cvt_pk_bf16_f32 v220, v200, v201
  v_cvt_pk_bf16_f32 v221, v202, v203
  v_cvt_pk_bf16_f32 v222, v204, v205
  v_cvt_pk_bf16_f32 v223, v206, v207
  s_nop 1
  v_mfma_f32_32x32x16_bf16 a[0:15], v[96:99], v[216:219], a[0:15]
  v_mfma_f32_32x32x16_bf16 a[16:31], v[100:103], v[216:219], a[16:31]
  v_mfma_f32_32x32x16_bf16 a[32:47], v[96:99], v[220:223], a[32:47]
  v_mfma_f32_32x32x16_bf16 a[48:63], v[100:103], v[220:223], a[48:63]
  s_lshl_b32 s6, s3, 12
  v_add_u32 v3, s6, v2
  s_nop 15
  ds_write_b128 v3, a[0:3] offset:0
  ds_write_b128 v3, a[4:7] offset:1024
  ds_write_b128 v3, a[8:11] offset:2048
  ds_write_b128 v3, a[12:15] offset:3072
  ds_write_b128 v3, a[16:19] offset:16384
  ds_write_b128 v3, a[20:23] offset:17408
  ds_write_b128 v3, a[24:27] offset:18432
  ds_write_b128 v3, a[28:31] offset:19456
  ds_write_b128 v3, a[32:35] offset:32768
  ds_write_b128 v3, a[36:39] offset:33792
  ds_write_b128 v3, a[40:43] offset:34816
  ds_write_b128 v3, a[44:47] offset:35840
  ds_write_b128 v3, a[48:51] offset:49152
  ds_write_b128 v3, a[52:55] offset:50176
  ds_write_b128 v3, a[56:59] offset:51200
  ds_write_b128 v3, a[60:63] offset:52224
  s_waitcnt lgkmcnt(0)
  s_barrier
  s_lshl_b32 s6, s3, 14
  v_add_u32 v3, s6, v2
  ds_read_b128 v[32:35], v3 offset:0
  ds_read_b128 v[36:39], v3 offset:1024
  ds_read_b128 v[40:43], v3 offset:2048
  ds_read_b128 v[44:47], v3 offset:3072
  ds_read_b128 v[48:51], v3 offset:4096
  ds_read_b128 v[52:55], v3 offset:5120
  ds_read_b128 v[56:59], v3 offset:6144
  ds_read_b128 v[60:63], v3 offset:7168
  ds_read_b128 v[64:67], v3 offset:8192
  ds_read_b128 v[68:71], v3 offset:9216
  ds_read_b128 v[72:75], v3 offset:10240
  ds_read_b128 v[76:79], v3 offset:11264
  ds_read_b128 v[80:83], v3 offset:12288
  ds_read_b128 v[84:87], v3 offset:13312
  ds_read_b128 v[88:91], v3 offset:14336
  ds_read_b128 v[92:95], v3 offset:15360
  s_waitcnt lgkmcnt(0)
  v_add_f32 v32, v32, v48
  v_add_f32 v64, v64, v80
  v_add_f32 v32, v32, v64
  v_add_f32 v33, v33, v49
  v_add_f32 v65, v65, v81
  v_add_f32 v33, v33, v65
  v_add_f32 v34, v34, v50
  v_add_f32 v66, v66, v82
  v_add_f32 v34, v34, v66
  v_add_f32 v35, v35, v51
  v_add_f32 v67, v67, v83
  v_add_f32 v35, v35, v67
  v_add_f32 v36, v36, v52
  v_add_f32 v68, v68, v84
  v_add_f32 v36, v36, v68
  v_add_f32 v37, v37, v53
  v_add_f32 v69, v69, v85
  v_add_f32 v37, v37, v69
  v_add_f32 v38, v38, v54
  v_add_f32 v70, v70, v86
  v_add_f32 v38, v38, v70
  v_add_f32 v39, v39, v55
  v_add_f32 v71, v71, v87
  v_add_f32 v39, v39, v71
  v_add_f32 v40, v40, v56
  v_add_f32 v72, v72, v88
  v_add_f32 v40, v40, v72
  v_add_f32 v41, v41, v57
  v_add_f32 v73, v73, v89
  v_add_f32 v41, v41, v73
  v_add_f32 v42, v42, v58
  v_add_f32 v74, v74, v90
  v_add_f32 v42, v42, v74
  v_add_f32 v43, v43, v59
  v_add_f32 v75, v75, v91
  v_add_f32 v43, v43, v75
  v_add_f32 v44, v44, v60
  v_add_f32 v76, v76, v92
  v_add_f32 v44, v44, v76
  v_add_f32 v45, v45, v61
  v_add_f32 v77, v77, v93
  v_add_f32 v45, v45, v77
  v_add_f32 v46, v46, v62
  v_add_f32 v78, v78, v94
  v_add_f32 v46, v46, v78
  v_add_f32 v47, v47, v63
  v_add_f32 v79, v79, v95
  v_add_f32 v47, v47, v79
  s_waitcnt vmcnt(0)
  v_mov_b32 v8, 0
  v_mov_b32 v9, 0
  v_mov_b32 v10, 0x3f803f80
  v_cvt_pk_bf16_f32 v13, v32, v33
  v_lshlrev_b32 v14, 16, v13
  v_and_b32 v15, 0xffff0000, v13
  v_lshlrev_b32 v12, 16, v224
  v_and_b32 v11, 0xffff0000, v224
  v_add_f32 v14, v14, v12
  v_add_f32 v15, v15, v11
  v_cvt_pk_bf16_f32 v96, v14, v15
  v_dot2_f32_bf16 v8, v96, v10, v8
  v_dot2_f32_bf16 v9, v96, v96, v9
  v_cvt_pk_bf16_f32 v13, v34, v35
  v_lshlrev_b32 v14, 16, v13
  v_and_b32 v15, 0xffff0000, v13
  v_lshlrev_b32 v12, 16, v225
  v_and_b32 v11, 0xffff0000, v225
  v_add_f32 v14, v14, v12
  v_add_f32 v15, v15, v11
  v_cvt_pk_bf16_f32 v97, v14, v15
  v_dot2_f32_bf16 v8, v97, v10, v8
  v_dot2_f32_bf16 v9, v97, v97, v9
  buffer_store_dwordx2 v[96:97], v6, s[24:27], 0 offen offset:0
  v_cvt_pk_bf16_f32 v13, v36, v37
  v_lshlrev_b32 v14, 16, v13
  v_and_b32 v15, 0xffff0000, v13
  v_lshlrev_b32 v12, 16, v226
  v_and_b32 v11, 0xffff0000, v226
  v_add_f32 v14, v14, v12
  v_add_f32 v15, v15, v11
  v_cvt_pk_bf16_f32 v98, v14, v15
  v_dot2_f32_bf16 v8, v98, v10, v8
  v_dot2_f32_bf16 v9, v98, v98, v9
  v_cvt_pk_bf16_f32 v13, v38, v39
  v_lshlrev_b32 v14, 16, v13
  v_and_b32 v15, 0xffff0000, v13
  v_lshlrev_b32 v12, 16, v227
  v_and_b32 v11, 0xffff0000, v227
  v_add_f32 v14, v14, v12
  v_add_f32 v15, v15, v11
  v_cvt_pk_bf16_f32 v99, v14, v15
  v_dot2_f32_bf16 v8, v99, v10, v8
  v_dot2_f32_bf16 v9, v99, v99, v9
  buffer_store_dwordx2 v[98:99], v6, s[24:27], 0 offen offset:16
  v_cvt_pk_bf16_f32 v13, v40, v41
  v_lshlrev_b32 v14, 16, v13
  v_and_b32 v15, 0xffff0000, v13
  v_lshlrev_b32 v12, 16, v228
  v_and_b32 v11, 0xffff0000, v228
  v_add_f32 v14, v14, v12
  v_add_f32 v15, v15, v11
  v_cvt_pk_bf16_f32 v100, v14, v15
  v_dot2_f32_bf16 v8, v100, v10, v8
  v_dot2_f32_bf16 v9, v100, v100, v9
  v_cvt_pk_bf16_f32 v13, v42, v43
  v_lshlrev_b32 v14, 16, v13
  v_and_b32 v15, 0xffff0000, v13
  v_lshlrev_b32 v12, 16, v229
  v_and_b32 v11, 0xffff0000, v229
  v_add_f32 v14, v14, v12
  v_add_f32 v15, v15, v11
  v_cvt_pk_bf16_f32 v101, v14, v15
  v_dot2_f32_bf16 v8, v101, v10, v8
  v_dot2_f32_bf16 v9, v101, v101, v9
  buffer_store_dwordx2 v[100:101], v6, s[24:27], 0 offen offset:32
  v_cvt_pk_bf16_f32 v13, v44, v45
  v_lshlrev_b32 v14, 16, v13
  v_and_b32 v15, 0xffff0000, v13
  v_lshlrev_b32 v12, 16, v230
  v_and_b32 v11, 0xffff0000, v230
  v_add_f32 v14, v14, v12
  v_add_f32 v15, v15, v11
  v_cvt_pk_bf16_f32 v102, v14, v15
  v_dot2_f32_bf16 v8, v102, v10, v8
  v_dot2_f32_bf16 v9, v102, v102, v9
  v_cvt_pk_bf16_f32 v13, v46, v47
  v_lshlrev_b32 v14, 16, v13
  v_and_b32 v15, 0xffff0000, v13
  v_lshlrev_b32 v12, 16, v231
  v_and_b32 v11, 0xffff0000, v231
  v_add_f32 v14, v14, v12
  v_add_f32 v15, v15, v11
  v_cvt_pk_bf16_f32 v103, v14, v15
  v_dot2_f32_bf16 v8, v103, v10, v8
  v_dot2_f32_bf16 v9, v103, v103, v9
  buffer_store_dwordx2 v[102:103], v6, s[24:27], 0 offen offset:48
  v_mov_b32 v12, v8
  v_mov_b32 v13, v9
  s_nop 1
  v_permlane32_swap_b32 v8, v12
  v_permlane32_swap_b32 v9, v13
  s_nop 1
  v_add_f32 v8, v8, v12
  v_add_f32 v9, v9, v13
  v_lshrrev_b32 v3, 10, v6
  v_lshlrev_b32 v3, 7, v3
  s_lshl_b32 s6, s5, 1
  s_and_b32 s7, s3, 1
  s_add_u32 s6, s6, s7
  s_lshl_b32 s6, s6, 3
  v_add_u32 v3, s6, v3
  s_mov_b32 exec_hi, 0
  buffer_store_dwordx2 v[8:9], v3, s[28:31], 0 offen
  s_endpgm
P2_END:
  s_endpgm
.globl p3_kernel
.p2align 8
.type p3_kernel,@function
p3_kernel:
  s_cmp_ge_u32 s2, 224
  s_cbranch_scc1 P3_END
  s_load_dwordx2 s[42:43], s[0:1], 32
  s_load_dwordx2 s[50:51], s[0:1], 64
  v_and_b32 v1, 63, v0
  v_lshrrev_b32 v2, 6, v0
  s_nop 0
  v_readfirstlane_b32 s3, v2
  s_and_b32 s37, s3, 3
  s_lshr_b32 s4, s37, 1
  s_and_b32 s5, s37, 1
  s_and_b32 s6, s2, 7
  s_lshr_b32 s7, s2, 3
  s_and_b32 s31, s6, 3
  s_lshl_b32 s31, s31, 2
  s_and_b32 s32, s7, 3
  s_add_u32 s31, s31, s32
  s_lshr_b32 s32, s6, 2
  s_mul_i32 s32, s32, 7
  s_lshr_b32 s7, s7, 2
  s_add_u32 s32, s32, s7
  s_mov_b32 s52, 0x3fb8aa3b
  s_mov_b32 s53, 0x3fb8aa3b
  s_mov_b32 s54, 0xbfb8aa3b
  s_mov_b32 s55, 0xbfb8aa3b
  s_mov_b32 s56, 0x358637bd
  s_mov_b32 s57, 0x358637bd
  s_waitcnt lgkmcnt(0)
  s_add_u32 s8, s50, 0x200000
  s_addc_u32 s9, s51, 0
  s_mov_b32 s10, 0x200000
  s_mov_b32 s11, 0x20000
  s_mov_b32 s12, s42
  s_mov_b32 s13, s43
  s_mov_b32 s14, 0x1c0000
  s_mov_b32 s15, 0x20000
  s_add_u32 s16, s50, 0x400000
  s_addc_u32 s17, s51, 0
  s_mov_b32 s18, 0x700000
  s_mov_b32 s19, 0x20000
  s_add_u32 s20, s50, 0xd50000
  s_addc_u32 s21, s51, 0
  s_mov_b32 s22, 0x40000
  s_mov_b32 s23, 0x20000
  s_cmp_ge_u32 s3, 4
  s_cbranch_scc0 P3_COMPUTE
  v_and_b32 v2, 31, v1
  s_lshl_b32 s6, s31, 7
  s_lshl_b32 s7, s4, 6
  s_add_u32 s6, s6, s7
  v_add_u32 v2, s6, v2
  v_lshlrev_b32 v2, 7, v2
  v_lshrrev_b32 v3, 5, v1
  v_lshl_add_u32 v2, v3, 6, v2
  s_xor_b32 s6, s5, 1
  s_lshl_b32 s6, s6, 12
  v_add_u32 v3, s6, v2
  buffer_load_dwordx4 v[204:207], v3, s[20:23], 0 offen offset:0
  buffer_load_dwordx4 v[208:211], v3, s[20:23], 0 offen offset:16
  buffer_load_dwordx4 v[212:215], v3, s[20:23], 0 offen offset:32
  buffer_load_dwordx4 v[216:219], v3, s[20:23], 0 offen offset:48
  v_lshrrev_b32 v2, 3, v1
  v_lshlrev_b32 v2, 10, v2
  v_and_b32 v3, 7, v1
  v_lshrrev_b32 v4, 4, v1
  v_xor_b32 v5, v3, v4
  v_lshl_add_u32 v32, v5, 4, v2
  v_xor_b32 v5, 4, v5
  v_lshl_add_u32 v33, v5, 4, v2
  v_and_b32 v3, 15, v1
  v_lshlrev_b32 v5, 2, v4
  v_xor_b32 v10, v3, v5
  s_mov_b32 s6, 3584
  v_mul_lo_u32 v11, v4, s6
  v_lshl_add_u32 v34, v10, 4, v11
  s_lshl_b32 s28, s31, 17
  s_lshl_b32 s6, s37, 15
  s_add_u32 s28, s28, s6
  s_lshl_b32 s30, s37, 12
  s_add_u32 s30, s30, 4096
  s_mul_i32 s29, s37, 57344
  s_lshl_b32 s6, s32, 8
  s_add_u32 s29, s29, s6
  s_add_u32 m0, s30, 0
  s_add_u32 s7, s28, 0
  buffer_load_dwordx4 v32, s[8:11], s7 offen lds
  s_add_u32 m0, s30, 1024
  s_add_u32 s7, s28, 8192
  buffer_load_dwordx4 v33, s[8:11], s7 offen lds
  s_add_u32 m0, s30, 2048
  s_add_u32 s7, s28, 16384
  buffer_load_dwordx4 v32, s[8:11], s7 offen lds
  s_add_u32 m0, s30, 3072
  s_add_u32 s7, s28, 24576
  buffer_load_dwordx4 v33, s[8:11], s7 offen lds
  s_add_u32 m0, s30, 16384
  s_add_u32 s7, s29, 0
  buffer_load_dwordx4 v34, s[12:15], s7 offen lds
  s_add_u32 m0, s30, 17408
  s_add_u32 s7, s29, 14336
  buffer_load_dwordx4 v34, s[12:15], s7 offen lds
  s_add_u32 m0, s30, 18432
  s_add_u32 s7, s29, 28672
  buffer_load_dwordx4 v34, s[12:15], s7 offen lds
  s_add_u32 m0, s30, 19456
  s_add_u32 s7, s29, 43008
  buffer_load_dwordx4 v34, s[12:15], s7 offen lds
  s_add_u32 m0, s30, 32768
  s_add_u32 s7, s28, 128
  buffer_load_dwordx4 v32, s[8:11], s7 offen lds
  s_add_u32 m0, s30, 33792
  s_add_u32 s7, s28, 8320
  buffer_load_dwordx4 v33, s[8:11], s7 offen lds
  s_add_u32 m0, s30, 34816
  s_add_u32 s7, s28, 16512
  buffer_load_dwordx4 v32, s[8:11], s7 offen lds
  s_add_u32 m0, s30, 35840
  s_add_u32 s7, s28, 24704
  buffer_load_dwordx4 v33, s[8:11], s7 offen lds
  s_add_u32 m0, s30, 49152
  s_add_u32 s7, s29, 229376
  buffer_load_dwordx4 v34, s[12:15], s7 offen lds
  s_add_u32 m0, s30, 50176
  s_add_u32 s7, s29, 243712
  buffer_load_dwordx4 v34, s[12:15], s7 offen lds
  s_add_u32 m0, s30, 51200
  s_add_u32 s7, s29, 258048
  buffer_load_dwordx4 v34, s[12:15], s7 offen lds
  s_add_u32 m0, s30, 52224
  s_add_u32 s7, s29, 272384
  buffer_load_dwordx4 v34, s[12:15], s7 offen lds
  s_waitcnt vmcnt(8)
  s_barrier
  s_add_u32 m0, s30, 65536
  s_add_u32 s7, s28, 256
  buffer_load_dwordx4 v32, s[8:11], s7 offen lds
  s_add_u32 m0, s30, 66560
  s_add_u32 s7, s28, 8448
  buffer_load_dwordx4 v33, s[8:11], s7 offen lds
  s_add_u32 m0, s30, 67584
  s_add_u32 s7, s28, 16640
  buffer_load_dwordx4 v32, s[8:11], s7 offen lds
  s_add_u32 m0, s30, 68608
  s_add_u32 s7, s28, 24832
  buffer_load_dwordx4 v33, s[8:11], s7 offen lds
  s_add_u32 m0, s30, 81920
  s_add_u32 s7, s29, 458752
  buffer_load_dwordx4 v34, s[12:15], s7 offen lds
  s_add_u32 m0, s30, 82944
  s_add_u32 s7, s29, 473088
  buffer_load_dwordx4 v34, s[12:15], s7 offen lds
  s_add_u32 m0, s30, 83968
  s_add_u32 s7, s29, 487424
  buffer_load_dwordx4 v34, s[12:15], s7 offen lds
  s_add_u32 m0, s30, 84992
  s_add_u32 s7, s29, 501760
  buffer_load_dwordx4 v34, s[12:15], s7 offen lds
  s_add_u32 m0, s30, 98304
  s_add_u32 s7, s28, 384
  buffer_load_dwordx4 v32, s[8:11], s7 offen lds
  s_add_u32 m0, s30, 99328
  s_add_u32 s7, s28, 8576
  buffer_load_dwordx4 v33, s[8:11], s7 offen lds
  s_add_u32 m0, s30, 100352
  s_add_u32 s7, s28, 16768
  buffer_load_dwordx4 v32, s[8:11], s7 offen lds
  s_add_u32 m0, s30, 101376
  s_add_u32 s7, s28, 24960
  buffer_load_dwordx4 v33, s[8:11], s7 offen lds
  s_add_u32 m0, s30, 114688
  s_add_u32 s7, s29, 688128
  buffer_load_dwordx4 v34, s[12:15], s7 offen lds
  s_add_u32 m0, s30, 115712
  s_add_u32 s7, s29, 702464
  buffer_load_dwordx4 v34, s[12:15], s7 offen lds
  s_add_u32 m0, s30, 116736
  s_add_u32 s7, s29, 716800
  buffer_load_dwordx4 v34, s[12:15], s7 offen lds
  s_add_u32 m0, s30, 117760
  s_add_u32 s7, s29, 731136
  buffer_load_dwordx4 v34, s[12:15], s7 offen lds
  s_waitcnt vmcnt(16)
  s_barrier
  s_add_u32 m0, s30, 0
  s_add_u32 s7, s28, 512
  buffer_load_dwordx4 v32, s[8:11], s7 offen lds
  s_add_u32 m0, s30, 1024
  s_add_u32 s7, s28, 8704
  buffer_load_dwordx4 v33, s[8:11], s7 offen lds
  s_add_u32 m0, s30, 2048
  s_add_u32 s7, s28, 16896
  buffer_load_dwordx4 v32, s[8:11], s7 offen lds
  s_add_u32 m0, s30, 3072
  s_add_u32 s7, s28, 25088
  buffer_load_dwordx4 v33, s[8:11], s7 offen lds
  s_add_u32 m0, s30, 16384
  s_add_u32 s7, s29, 917504
  buffer_load_dwordx4 v34, s[12:15], s7 offen lds
  s_add_u32 m0, s30, 17408
  s_add_u32 s7, s29, 931840
  buffer_load_dwordx4 v34, s[12:15], s7 offen lds
  s_add_u32 m0, s30, 18432
  s_add_u32 s7, s29, 946176
  buffer_load_dwordx4 v34, s[12:15], s7 offen lds
  s_add_u32 m0, s30, 19456
  s_add_u32 s7, s29, 960512
  buffer_load_dwordx4 v34, s[12:15], s7 offen lds
  s_waitcnt vmcnt(16)
  s_barrier
  s_add_u32 m0, s30, 32768
  s_add_u32 s7, s28, 640
  buffer_load_dwordx4 v32, s[8:11], s7 offen lds
  s_add_u32 m0, s30, 33792
  s_add_u32 s7, s28, 8832
  buffer_load_dwordx4 v33, s[8:11], s7 offen lds
  s_add_u32 m0, s30, 34816
  s_add_u32 s7, s28, 17024
  buffer_load_dwordx4 v32, s[8:11], s7 offen lds
  s_add_u32 m0, s30, 35840
  s_add_u32 s7, s28, 25216
  buffer_load_dwordx4 v33, s[8:11], s7 offen lds
  s_add_u32 m0, s30, 49152
  s_add_u32 s7, s29, 1146880
  buffer_load_dwordx4 v34, s[12:15], s7 offen lds
  s_add_u32 m0, s30, 50176
  s_add_u32 s7, s29, 1161216
  buffer_load_dwordx4 v34, s[12:15], s7 offen lds
  s_add_u32 m0, s30, 51200
  s_add_u32 s7, s29, 1175552
  buffer_load_dwordx4 v34, s[12:15], s7 offen lds
  s_add_u32 m0, s30, 52224
  s_add_u32 s7, s29, 1189888
  buffer_load_dwordx4 v34, s[12:15], s7 offen lds
  s_waitcnt vmcnt(16)
  s_barrier
  s_add_u32 m0, s30, 65536
  s_add_u32 s7, s28, 768
  buffer_load_dwordx4 v32, s[8:11], s7 offen lds
  s_add_u32 m0, s30, 66560
  s_add_u32 s7, s28, 8960
  buffer_load_dwordx4 v33, s[8:11], s7 offen lds
  s_add_u32 m0, s30, 67584
  s_add_u32 s7, s28, 17152
  buffer_load_dwordx4 v32, s[8:11], s7 offen lds
  s_add_u32 m0, s30, 68608
  s_add_u32 s7, s28, 25344
  buffer_load_dwordx4 v33, s[8:11], s7 offen lds
  s_add_u32 m0, s30, 81920
  s_add_u32 s7, s29, 1376256
  buffer_load_dwordx4 v34, s[12:15], s7 offen lds
  s_add_u32 m0, s30, 82944
  s_add_u32 s7, s29, 1390592
  buffer_load_dwordx4 v34, s[12:15], s7 offen lds
  s_add_u32 m0, s30, 83968
  s_add_u32 s7, s29, 1404928
  buffer_load_dwordx4 v34, s[12:15], s7 offen lds
  s_add_u32 m0, s30, 84992
  s_add_u32 s7, s29, 1419264
  buffer_load_dwordx4 v34, s[12:15], s7 offen lds
  s_waitcnt vmcnt(16)
  s_barrier
  s_add_u32 m0, s30, 98304
  s_add_u32 s7, s28, 896
  buffer_load_dwordx4 v32, s[8:11], s7 offen lds
  s_add_u32 m0, s30, 99328
  s_add_u32 s7, s28, 9088
  buffer_load_dwordx4 v33, s[8:11], s7 offen lds
  s_add_u32 m0, s30, 100352
  s_add_u32 s7, s28, 17280
  buffer_load_dwordx4 v32, s[8:11], s7 offen lds
  s_add_u32 m0, s30, 101376
  s_add_u32 s7, s28, 25472
  buffer_load_dwordx4 v33, s[8:11], s7 offen lds
  s_add_u32 m0, s30, 114688
  s_add_u32 s7, s29, 1605632
  buffer_load_dwordx4 v34, s[12:15], s7 offen lds
  s_add_u32 m0, s30, 115712
  s_add_u32 s7, s29, 1619968
  buffer_load_dwordx4 v34, s[12:15], s7 offen lds
  s_add_u32 m0, s30, 116736
  s_add_u32 s7, s29, 1634304
  buffer_load_dwordx4 v34, s[12:15], s7 offen lds
  s_add_u32 m0, s30, 117760
  s_add_u32 s7, s29, 1648640
  buffer_load_dwordx4 v34, s[12:15], s7 offen lds
  s_waitcnt vmcnt(16)
  s_barrier
  s_waitcnt vmcnt(8)
  s_barrier
  s_waitcnt vmcnt(0)
  s_barrier
  s_barrier
  v_lshlrev_b32 v2, 4, v1
  s_lshl_b32 s6, s37, 13
  v_add_u32 v2, s6, v2
  ds_read_b128 v[64:67], v2 offset:4096
  ds_read_b128 v[68:71], v2 offset:5120
  ds_read_b128 v[72:75], v2 offset:6144
  ds_read_b128 v[76:79], v2 offset:7168
  ds_read_b128 v[80:83], v2 offset:8192
  ds_read_b128 v[84:87], v2 offset:9216
  ds_read_b128 v[88:91], v2 offset:10240
  ds_read_b128 v[92:95], v2 offset:11264
  s_waitcnt vmcnt(0)
  v_add_f32 v204, v204, v206
  v_add_f32 v205, v205, v207
  v_add_f32 v204, v204, v208
  v_add_f32 v205, v205, v209
  v_add_f32 v204, v204, v210
  v_add_f32 v205, v205, v211
  v_add_f32 v204, v204, v212
  v_add_f32 v205, v205, v213
  v_add_f32 v204, v204, v214
  v_add_f32 v205, v205, v215
  v_add_f32 v204, v204, v216
  v_add_f32 v205, v205, v217
  v_add_f32 v204, v204, v218
  v_add_f32 v205, v205, v219
  v_mov_b32 v206, v204
  v_mov_b32 v207, v205
  s_nop 1
  v_permlane32_swap_b32 v204, v206
  v_permlane32_swap_b32 v205, v207
  s_nop 1
  v_add_f32 v204, v204, v206
  v_add_f32 v205, v205, v207
  v_mul_f32 v204, 0x3b000000, v204
  v_mul_f32 v205, 0x3b000000, v205
  v_fma_f32 v205, -v204, v204, v205
  v_max_f32 v205, 0, v205
  v_cvt_pk_bf16_f32 v204, v204, v204
  v_lshlrev_b32 v204, 16, v204
  v_cvt_pk_bf16_f32 v205, v205, v205
  v_lshlrev_b32 v205, 16, v205
  v_add_f32 v205, 0x3727c5ac, v205
  v_cvt_pk_bf16_f32 v205, v205, v205
  v_lshlrev_b32 v205, 16, v205
  v_sqrt_f32 v205, v205
  s_nop 0
  v_cvt_pk_bf16_f32 v205, v205, v205
  v_lshlrev_b32 v205, 16, v205
  v_rcp_f32 v12, v205
  s_nop 0
  v_mul_f32 v14, v204, v12
  v_lshrrev_b32 v3, 5, v1
  v_lshlrev_b32 v5, 4, v3
  s_lshl_b32 s6, s5, 8
  v_add_u32 v5, s6, v5
  s_xor_b32 s6, s4, 0
  s_lshl_b32 s6, s6, 7
  v_add_u32 v6, s6, v5
  ds_read_b128 v[96:99], v6 offset:1024
  ds_read_b128 v[100:103], v6 offset:1056
  ds_read_b128 v[104:107], v6 offset:1088
  ds_read_b128 v[108:111], v6 offset:1120
  s_xor_b32 s6, s4, 1
  s_lshl_b32 s6, s6, 7
  v_add_u32 v6, s6, v5
  ds_read_b128 v[112:115], v6 offset:1024
  ds_read_b128 v[116:119], v6 offset:1056
  ds_read_b128 v[120:123], v6 offset:1088
  ds_read_b128 v[124:127], v6 offset:1120
  s_waitcnt lgkmcnt(0)
  s_lshl_b32 s34, s31, 2
  s_lshl_b32 s6, s4, 1
  s_add_u32 s34, s34, s6
  s_mul_i32 s34, s34, 112
  s_lshl_b32 s6, s32, 3
  s_add_u32 s34, s34, s6
  s_lshl_b32 s6, s5, 2
  s_add_u32 s34, s34, s6
  s_lshl_b32 s34, s34, 10
  v_lshlrev_b32 v6, 4, v1
  s_xor_b32 s35, s5, 1
  s_mul_i32 s35, s35, 114688
  s_add_u32 s35, s35, s34
  s_xor_b32 s36, s4, 0
  s_lshl_b32 s36, s36, 11
  s_add_u32 s36, s36, s35
  v_pk_mul_f32 v[132:133], v[64:65], v[12:13] op_sel_hi:[1,0]
  v_pk_mul_f32 v[134:135], v[66:67], v[12:13] op_sel_hi:[1,0]
  v_pk_mul_f32 v[136:137], v[68:69], v[12:13] op_sel_hi:[1,0]
  v_pk_mul_f32 v[138:139], v[70:71], v[12:13] op_sel_hi:[1,0]
  v_pk_fma_f32 v[132:133], v[96:97], v[14:15], v[132:133] op_sel_hi:[1,0,1] neg_lo:[0,1,0] neg_hi:[0,1,0]
  v_pk_fma_f32 v[134:135], v[98:99], v[14:15], v[134:135] op_sel_hi:[1,0,1] neg_lo:[0,1,0] neg_hi:[0,1,0]
  v_pk_fma_f32 v[136:137], v[100:101], v[14:15], v[136:137] op_sel_hi:[1,0,1] neg_lo:[0,1,0] neg_hi:[0,1,0]
  v_pk_fma_f32 v[138:139], v[102:103], v[14:15], v[138:139] op_sel_hi:[1,0,1] neg_lo:[0,1,0] neg_hi:[0,1,0]
  v_cvt_pk_bf16_f32 v148, v132, v133
  v_cvt_pk_bf16_f32 v149, v134, v135
  v_cvt_pk_bf16_f32 v150, v136, v137
  v_cvt_pk_bf16_f32 v151, v138, v139
  v_lshlrev_b32 v132, 16, v148
  v_and_b32 v133, 0xffff0000, v148
  v_lshlrev_b32 v134, 16, v149
  v_and_b32 v135, 0xffff0000, v149
  v_lshlrev_b32 v136, 16, v150
  v_and_b32 v137, 0xffff0000, v150
  v_lshlrev_b32 v138, 16, v151
  v_and_b32 v139, 0xffff0000, v151
  v_pk_mul_f32 v[140:141], v[132:133], s[54:55]
  v_pk_mul_f32 v[142:143], v[134:135], s[54:55]
  v_pk_mul_f32 v[144:145], v[136:137], s[54:55]
  v_pk_mul_f32 v[146:147], v[138:139], s[54:55]
  v_exp_f32 v140, v140
  v_exp_f32 v141, v141
  v_exp_f32 v142, v142
  v_exp_f32 v143, v143
  v_exp_f32 v144, v144
  v_exp_f32 v145, v145
  v_exp_f32 v146, v146
  v_exp_f32 v147, v147
  v_pk_add_f32 v[140:141], v[140:141], 1.0 op_sel_hi:[1,0]
  v_pk_add_f32 v[142:143], v[142:143], 1.0 op_sel_hi:[1,0]
  v_pk_add_f32 v[144:145], v[144:145], 1.0 op_sel_hi:[1,0]
  v_pk_add_f32 v[146:147], v[146:147], 1.0 op_sel_hi:[1,0]
  v_rcp_f32 v140, v140
  v_rcp_f32 v141, v141
  v_rcp_f32 v142, v142
  v_rcp_f32 v143, v143
  v_rcp_f32 v144, v144
  v_rcp_f32 v145, v145
  v_rcp_f32 v146, v146
  v_rcp_f32 v147, v147
  s_nop 0
  v_pk_mul_f32 v[132:133], v[132:133], v[140:141]
  v_pk_mul_f32 v[134:135], v[134:135], v[142:143]
  v_pk_mul_f32 v[136:137], v[136:137], v[144:145]
  v_pk_mul_f32 v[138:139], v[138:139], v[146:147]
  v_cvt_pk_bf16_f32 v128, v132, v133
  v_cvt_pk_bf16_f32 v129, v134, v135
  v_cvt_pk_bf16_f32 v130, v136, v137
  v_cvt_pk_bf16_f32 v131, v138, v139
  s_add_u32 s7, s36, 0
  buffer_store_dwordx4 v[128:131], v6, s[16:19], s7 offen
  v_pk_mul_f32 v[132:133], v[72:73], v[12:13] op_sel_hi:[1,0]
  v_pk_mul_f32 v[134:135], v[74:75], v[12:13] op_sel_hi:[1,0]
  v_pk_mul_f32 v[136:137], v[76:77], v[12:13] op_sel_hi:[1,0]
  v_pk_mul_f32 v[138:139], v[78:79], v[12:13] op_sel_hi:[1,0]
  v_pk_fma_f32 v[132:133], v[104:105], v[14:15], v[132:133] op_sel_hi:[1,0,1] neg_lo:[0,1,0] neg_hi:[0,1,0]
  v_pk_fma_f32 v[134:135], v[106:107], v[14:15], v[134:135] op_sel_hi:[1,0,1] neg_lo:[0,1,0] neg_hi:[0,1,0]
  v_pk_fma_f32 v[136:137], v[108:109], v[14:15], v[136:137] op_sel_hi:[1,0,1] neg_lo:[0,1,0] neg_hi:[0,1,0]
  v_pk_fma_f32 v[138:139], v[110:111], v[14:15], v[138:139] op_sel_hi:[1,0,1] neg_lo:[0,1,0] neg_hi:[0,1,0]
  v_cvt_pk_bf16_f32 v148, v132, v133
  v_cvt_pk_bf16_f32 v149, v134, v135
  v_cvt_pk_bf16_f32 v150, v136, v137
  v_cvt_pk_bf16_f32 v151, v138, v139
  v_lshlrev_b32 v132, 16, v148
  v_and_b32 v133, 0xffff0000, v148
  v_lshlrev_b32 v134, 16, v149
  v_and_b32 v135, 0xffff0000, v149
  v_lshlrev_b32 v136, 16, v150
  v_and_b32 v137, 0xffff0000, v150
  v_lshlrev_b32 v138, 16, v151
  v_and_b32 v139, 0xffff0000, v151
  v_pk_mul_f32 v[140:141], v[132:133], s[54:55]
  v_pk_mul_f32 v[142:143], v[134:135], s[54:55]
  v_pk_mul_f32 v[144:145], v[136:137], s[54:55]
  v_pk_mul_f32 v[146:147], v[138:139], s[54:55]
  v_exp_f32 v140, v140
  v_exp_f32 v141, v141
  v_exp_f32 v142, v142
  v_exp_f32 v143, v143
  v_exp_f32 v144, v144
  v_exp_f32 v145, v145
  v_exp_f32 v146, v146
  v_exp_f32 v147, v147
  v_pk_add_f32 v[140:141], v[140:141], 1.0 op_sel_hi:[1,0]
  v_pk_add_f32 v[142:143], v[142:143], 1.0 op_sel_hi:[1,0]
  v_pk_add_f32 v[144:145], v[144:145], 1.0 op_sel_hi:[1,0]
  v_pk_add_f32 v[146:147], v[146:147], 1.0 op_sel_hi:[1,0]
  v_rcp_f32 v140, v140
  v_rcp_f32 v141, v141
  v_rcp_f32 v142, v142
  v_rcp_f32 v143, v143
  v_rcp_f32 v144, v144
  v_rcp_f32 v145, v145
  v_rcp_f32 v146, v146
  v_rcp_f32 v147, v147
  s_nop 0
  v_pk_mul_f32 v[132:133], v[132:133], v[140:141]
  v_pk_mul_f32 v[134:135], v[134:135], v[142:143]
  v_pk_mul_f32 v[136:137], v[136:137], v[144:145]
  v_pk_mul_f32 v[138:139], v[138:139], v[146:147]
  v_cvt_pk_bf16_f32 v128, v132, v133
  v_cvt_pk_bf16_f32 v129, v134, v135
  v_cvt_pk_bf16_f32 v130, v136, v137
  v_cvt_pk_bf16_f32 v131, v138, v139
  s_add_u32 s7, s36, 1024
  buffer_store_dwordx4 v[128:131], v6, s[16:19], s7 offen
  s_xor_b32 s36, s4, 1
  s_lshl_b32 s36, s36, 11
  s_add_u32 s36, s36, s35
  v_pk_mul_f32 v[132:133], v[80:81], v[12:13] op_sel_hi:[1,0]
  v_pk_mul_f32 v[134:135], v[82:83], v[12:13] op_sel_hi:[1,0]
  v_pk_mul_f32 v[136:137], v[84:85], v[12:13] op_sel_hi:[1,0]
  v_pk_mul_f32 v[138:139], v[86:87], v[12:13] op_sel_hi:[1,0]
  v_pk_fma_f32 v[132:133], v[112:113], v[14:15], v[132:133] op_sel_hi:[1,0,1] neg_lo:[0,1,0] neg_hi:[0,1,0]
  v_pk_fma_f32 v[134:135], v[114:115], v[14:15], v[134:135] op_sel_hi:[1,0,1] neg_lo:[0,1,0] neg_hi:[0,1,0]
  v_pk_fma_f32 v[136:137], v[116:117], v[14:15], v[136:137] op_sel_hi:[1,0,1] neg_lo:[0,1,0] neg_hi:[0,1,0]
  v_pk_fma_f32 v[138:139], v[118:119], v[14:15], v[138:139] op_sel_hi:[1,0,1] neg_lo:[0,1,0] neg_hi:[0,1,0]
  v_cvt_pk_bf16_f32 v148, v132, v133
  v_cvt_pk_bf16_f32 v149, v134, v135
  v_cvt_pk_bf16_f32 v150, v136, v137
  v_cvt_pk_bf16_f32 v151, v138, v139
  v_lshlrev_b32 v132, 16, v148
  v_and_b32 v133, 0xffff0000, v148
  v_lshlrev_b32 v134, 16, v149
  v_and_b32 v135, 0xffff0000, v149
  v_lshlrev_b32 v136, 16, v150
  v_and_b32 v137, 0xffff0000, v150
  v_lshlrev_b32 v138, 16, v151
  v_and_b32 v139, 0xffff0000, v151
  v_pk_mul_f32 v[140:141], v[132:133], s[54:55]
  v_pk_mul_f32 v[142:143], v[134:135], s[54:55]
  v_pk_mul_f32 v[144:145], v[136:137], s[54:55]
  v_pk_mul_f32 v[146:147], v[138:139], s[54:55]
  v_exp_f32 v140, v140
  v_exp_f32 v141, v141
  v_exp_f32 v142, v142
  v_exp_f32 v143, v143
  v_exp_f32 v144, v144
  v_exp_f32 v145, v145
  v_exp_f32 v146, v146
  v_exp_f32 v147, v147
  v_pk_add_f32 v[140:141], v[140:141], 1.0 op_sel_hi:[1,0]
  v_pk_add_f32 v[142:143], v[142:143], 1.0 op_sel_hi:[1,0]
  v_pk_add_f32 v[144:145], v[144:145], 1.0 op_sel_hi:[1,0]
  v_pk_add_f32 v[146:147], v[146:147], 1.0 op_sel_hi:[1,0]
  v_rcp_f32 v140, v140
  v_rcp_f32 v141, v141
  v_rcp_f32 v142, v142
  v_rcp_f32 v143, v143
  v_rcp_f32 v144, v144
  v_rcp_f32 v145, v145
  v_rcp_f32 v146, v146
  v_rcp_f32 v147, v147
  s_nop 0
  v_pk_mul_f32 v[132:133], v[132:133], v[140:141]
  v_pk_mul_f32 v[134:135], v[134:135], v[142:143]
  v_pk_mul_f32 v[136:137], v[136:137], v[144:145]
  v_pk_mul_f32 v[138:139], v[138:139], v[146:147]
  v_cvt_pk_bf16_f32 v128, v132, v133
  v_cvt_pk_bf16_f32 v129, v134, v135
  v_cvt_pk_bf16_f32 v130, v136, v137
  v_cvt_pk_bf16_f32 v131, v138, v139
  s_add_u32 s7, s36, 0
  buffer_store_dwordx4 v[128:131], v6, s[16:19], s7 offen
  v_pk_mul_f32 v[132:133], v[88:89], v[12:13] op_sel_hi:[1,0]
  v_pk_mul_f32 v[134:135], v[90:91], v[12:13] op_sel_hi:[1,0]
  v_pk_mul_f32 v[136:137], v[92:93], v[12:13] op_sel_hi:[1,0]
  v_pk_mul_f32 v[138:139], v[94:95], v[12:13] op_sel_hi:[1,0]
  v_pk_fma_f32 v[132:133], v[120:121], v[14:15], v[132:133] op_sel_hi:[1,0,1] neg_lo:[0,1,0] neg_hi:[0,1,0]
  v_pk_fma_f32 v[134:135], v[122:123], v[14:15], v[134:135] op_sel_hi:[1,0,1] neg_lo:[0,1,0] neg_hi:[0,1,0]
  v_pk_fma_f32 v[136:137], v[124:125], v[14:15], v[136:137] op_sel_hi:[1,0,1] neg_lo:[0,1,0] neg_hi:[0,1,0]
  v_pk_fma_f32 v[138:139], v[126:127], v[14:15], v[138:139] op_sel_hi:[1,0,1] neg_lo:[0,1,0] neg_hi:[0,1,0]
  v_cvt_pk_bf16_f32 v148, v132, v133
  v_cvt_pk_bf16_f32 v149, v134, v135
  v_cvt_pk_bf16_f32 v150, v136, v137
  v_cvt_pk_bf16_f32 v151, v138, v139
  v_lshlrev_b32 v132, 16, v148
  v_and_b32 v133, 0xffff0000, v148
  v_lshlrev_b32 v134, 16, v149
  v_and_b32 v135, 0xffff0000, v149
  v_lshlrev_b32 v136, 16, v150
  v_and_b32 v137, 0xffff0000, v150
  v_lshlrev_b32 v138, 16, v151
  v_and_b32 v139, 0xffff0000, v151
  v_pk_mul_f32 v[140:141], v[132:133], s[54:55]
  v_pk_mul_f32 v[142:143], v[134:135], s[54:55]
  v_pk_mul_f32 v[144:145], v[136:137], s[54:55]
  v_pk_mul_f32 v[146:147], v[138:139], s[54:55]
  v_exp_f32 v140, v140
  v_exp_f32 v141, v141
  v_exp_f32 v142, v142
  v_exp_f32 v143, v143
  v_exp_f32 v144, v144
  v_exp_f32 v145, v145
  v_exp_f32 v146, v146
  v_exp_f32 v147, v147
  v_pk_add_f32 v[140:141], v[140:141], 1.0 op_sel_hi:[1,0]
  v_pk_add_f32 v[142:143], v[142:143], 1.0 op_sel_hi:[1,0]
  v_pk_add_f32 v[144:145], v[144:145], 1.0 op_sel_hi:[1,0]
  v_pk_add_f32 v[146:147], v[146:147], 1.0 op_sel_hi:[1,0]
  v_rcp_f32 v140, v140
  v_rcp_f32 v141, v141
  v_rcp_f32 v142, v142
  v_rcp_f32 v143, v143
  v_rcp_f32 v144, v144
  v_rcp_f32 v145, v145
  v_rcp_f32 v146, v146
  v_rcp_f32 v147, v147
  s_nop 0
  v_pk_mul_f32 v[132:133], v[132:133], v[140:141]
  v_pk_mul_f32 v[134:135], v[134:135], v[142:143]
  v_pk_mul_f32 v[136:137], v[136:137], v[144:145]
  v_pk_mul_f32 v[138:139], v[138:139], v[146:147]
  v_cvt_pk_bf16_f32 v128, v132, v133
  v_cvt_pk_bf16_f32 v129, v134, v135
  v_cvt_pk_bf16_f32 v130, v136, v137
  v_cvt_pk_bf16_f32 v131, v138, v139
  s_add_u32 s7, s36, 1024
  buffer_store_dwordx4 v[128:131], v6, s[16:19], s7 offen
  s_endpgm
P3_COMPUTE:
  v_and_b32 v2, 31, v1
  s_lshl_b32 s6, s31, 7
  s_lshl_b32 s7, s4, 6
  s_add_u32 s6, s6, s7
  v_add_u32 v2, s6, v2
  v_lshlrev_b32 v2, 7, v2
  v_lshrrev_b32 v3, 5, v1
  v_lshl_add_u32 v2, v3, 6, v2
  s_xor_b32 s6, s5, 0
  s_lshl_b32 s6, s6, 12
  v_add_u32 v3, s6, v2
  buffer_load_dwordx4 v[188:191], v3, s[20:23], 0 offen offset:0
  buffer_load_dwordx4 v[192:195], v3, s[20:23], 0 offen offset:16
  buffer_load_dwordx4 v[196:199], v3, s[20:23], 0 offen offset:32
  buffer_load_dwordx4 v[200:203], v3, s[20:23], 0 offen offset:48
  v_and_b32 v2, 31, v1
  v_lshrrev_b32 v3, 5, v1
  v_lshrrev_b32 v4, 1, v2
  v_and_b32 v4, 7, v4
  v_xor_b32 v4, v4, v3
  v_lshlrev_b32 v5, 7, v2
  s_lshl_b32 s6, s4, 13
  s_add_u32 s6, s6, 4096
  v_add_u32 v5, s6, v5
  s_xor_b32 s6, s5, 0
  s_lshl_b32 s6, s6, 12
  v_xor_b32 v6, 0, v4
  v_lshl_add_u32 v6, v6, 4, v5
  v_add_u32 v144, s6, v6
  v_add_u32 v148, 0x10000, v144
  v_xor_b32 v6, 2, v4
  v_lshl_add_u32 v6, v6, 4, v5
  v_add_u32 v145, s6, v6
  v_add_u32 v149, 0x10000, v145
  v_xor_b32 v6, 4, v4
  v_lshl_add_u32 v6, v6, 4, v5
  v_add_u32 v146, s6, v6
  v_add_u32 v150, 0x10000, v146
  v_xor_b32 v6, 6, v4
  v_lshl_add_u32 v6, v6, 4, v5
  v_add_u32 v147, s6, v6
  v_add_u32 v151, 0x10000, v147
  s_xor_b32 s6, s5, 1
  s_lshl_b32 s6, s6, 12
  v_xor_b32 v6, 0, v4
  v_lshl_add_u32 v6, v6, 4, v5
  v_add_u32 v152, s6, v6
  v_add_u32 v156, 0x10000, v152
  v_xor_b32 v6, 2, v4
  v_lshl_add_u32 v6, v6, 4, v5
  v_add_u32 v153, s6, v6
  v_add_u32 v157, 0x10000, v153
  v_xor_b32 v6, 4, v4
  v_lshl_add_u32 v6, v6, 4, v5
  v_add_u32 v154, s6, v6
  v_add_u32 v158, 0x10000, v154
  v_xor_b32 v6, 6, v4
  v_lshl_add_u32 v6, v6, 4, v5
  v_add_u32 v155, s6, v6
  v_add_u32 v159, 0x10000, v155
  v_lshrrev_b32 v2, 4, v1
  v_and_b32 v3, 15, v1
  v_lshrrev_b32 v4, 5, v1
  v_lshlrev_b32 v4, 3, v4
  v_lshrrev_b32 v5, 2, v3
  v_add_u32 v4, v4, v5
  v_lshlrev_b32 v4, 8, v4
  v_and_b32 v6, 1, v2
  v_lshlrev_b32 v6, 1, v6
  v_bfe_u32 v7, v3, 1, 1
  v_add_u32 v6, v6, v7
  s_lshl_b32 s6, s5, 3
  v_add_u32 v6, s6, v6
  v_lshlrev_b32 v7, 2, v5
  v_and_b32 v8, 1, v3
  v_lshlrev_b32 v8, 3, v8
  v_add_u32 v4, 4096, v4
  s_xor_b32 s6, s4, 0
  s_lshl_b32 s6, s6, 2
  v_add_u32 v9, s6, v6
  v_xor_b32 v9, v9, v7
  v_lshlrev_b32 v9, 4, v9
  v_add3_u32 v160, v9, v4, v8
  v_add_u32 v162, 0x10000, v160
  s_xor_b32 s6, s4, 1
  s_lshl_b32 s6, s6, 2
  v_add_u32 v9, s6, v6
  v_xor_b32 v9, v9, v7
  v_lshlrev_b32 v9, 4, v9
  v_add3_u32 v161, v9, v4, v8
  v_add_u32 v163, 0x10000, v161
  v_and_b32 v2, 15, v1
  v_bfe_u32 v3, v1, 4, 1
  v_cmp_eq_u32 vcc, v2, v3
  v_mov_b32 v4, 0x3f803f80
  s_nop 0
  v_cndmask_b32 v24, 0, v4, vcc
  v_cndmask_b32 v25, 0, v4, vcc
  v_cndmask_b32 v26, 0, v4, vcc
  v_cndmask_b32 v27, 0, v4, vcc
  s_barrier
  ds_read_b128 v[96:99], v144 offset:0
  ds_read_b64_tr_b16 v[120:121], v160 offset:16384
  ds_read_b64_tr_b16 v[122:123], v160 offset:17408
  ds_read_b64_tr_b16 v[124:125], v161 offset:16384
  ds_read_b64_tr_b16 v[126:127], v161 offset:17408
  ds_read_b128 v[100:103], v152 offset:0
  ds_read_b128 v[104:107], v145 offset:0
  ds_read_b64_tr_b16 v[128:129], v160 offset:20480
  ds_read_b64_tr_b16 v[130:131], v160 offset:21504
  ds_read_b64_tr_b16 v[132:133], v161 offset:20480
  ds_read_b64_tr_b16 v[134:135], v161 offset:21504
  ds_read_b128 v[108:111], v153 offset:0
  s_waitcnt lgkmcnt(6)
  v_mfma_f32_32x32x16_bf16 v[32:47], v[120:123], v[96:99], 0
  ds_read_b128 v[112:115], v146 offset:0
  ds_read_b64_tr_b16 v[136:137], v160 offset:24576
  v_mfma_f32_16x16x32_bf16 v[184:187], v[24:27], v[120:123], 0
  v_mfma_f32_32x32x16_bf16 v[48:63], v[124:127], v[96:99], 0
  ds_read_b64_tr_b16 v[138:139], v160 offset:25600
  ds_read_b64_tr_b16 v[140:141], v161 offset:24576
  v_mfma_f32_32x32x16_bf16 v[64:79], v[120:123], v[100:103], 0
  ds_read_b64_tr_b16 v[142:143], v161 offset:25600
  ds_read_b128 v[116:119], v154 offset:0
  v_mfma_f32_32x32x16_bf16 v[80:95], v[124:127], v[100:103], 0
  s_waitcnt lgkmcnt(6)
  v_mfma_f32_32x32x16_bf16 v[32:47], v[128:131], v[104:107], v[32:47]
  ds_read_b128 v[96:99], v147 offset:0
  ds_read_b64_tr_b16 v[120:121], v160 offset:28672
  v_mfma_f32_16x16x32_bf16 v[184:187], v[24:27], v[128:131], v[184:187]
  v_mfma_f32_32x32x16_bf16 v[48:63], v[132:135], v[104:107], v[48:63]
  ds_read_b64_tr_b16 v[122:123], v160 offset:29696
  ds_read_b64_tr_b16 v[124:125], v161 offset:28672
  v_mfma_f32_32x32x16_bf16 v[64:79], v[128:131], v[108:111], v[64:79]
  ds_read_b64_tr_b16 v[126:127], v161 offset:29696
  ds_read_b128 v[100:103], v155 offset:0
  v_mfma_f32_32x32x16_bf16 v[80:95], v[132:135], v[108:111], v[80:95]
  s_waitcnt lgkmcnt(0)
  s_barrier
  v_mfma_f32_32x32x16_bf16 v[32:47], v[136:139], v[112:115], v[32:47]
  ds_read_b128 v[104:107], v144 offset:32768
  ds_read_b64_tr_b16 v[128:129], v160 offset:49152
  v_mfma_f32_16x16x32_bf16 v[184:187], v[24:27], v[136:139], v[184:187]
  v_mfma_f32_32x32x16_bf16 v[48:63], v[140:143], v[112:115], v[48:63]
  ds_read_b64_tr_b16 v[130:131], v160 offset:50176
  ds_read_b64_tr_b16 v[132:133], v161 offset:49152
  v_mfma_f32_32x32x16_bf16 v[64:79], v[136:139], v[116:119], v[64:79]
  ds_read_b64_tr_b16 v[134:135], v161 offset:50176
  ds_read_b128 v[108:111], v152 offset:32768
  v_mfma_f32_32x32x16_bf16 v[80:95], v[140:143], v[116:119], v[80:95]
  s_waitcnt lgkmcnt(6)
  v_mfma_f32_32x32x16_bf16 v[32:47], v[120:123], v[96:99], v[32:47]
  ds_read_b128 v[112:115], v145 offset:32768
  ds_read_b64_tr_b16 v[136:137], v160 offset:53248
  v_mfma_f32_16x16x32_bf16 v[184:187], v[24:27], v[120:123], v[184:187]
  v_mfma_f32_32x32x16_bf16 v[48:63], v[124:127], v[96:99], v[48:63]
  ds_read_b64_tr_b16 v[138:139], v160 offset:54272
  ds_read_b64_tr_b16 v[140:141], v161 offset:53248
  v_mfma_f32_32x32x16_bf16 v[64:79], v[120:123], v[100:103], v[64:79]
  ds_read_b64_tr_b16 v[142:143], v161 offset:54272
  ds_read_b128 v[116:119], v153 offset:32768
  v_mfma_f32_32x32x16_bf16 v[80:95], v[124:127], v[100:103], v[80:95]
  s_waitcnt lgkmcnt(6)
  v_mfma_f32_32x32x16_bf16 v[32:47], v[128:131], v[104:107], v[32:47]
  ds_read_b128 v[96:99], v146 offset:32768
  ds_read_b64_tr_b16 v[120:121], v160 offset:57344
  v_mfma_f32_16x16x32_bf16 v[184:187], v[24:27], v[128:131], v[184:187]
  v_mfma_f32_32x32x16_bf16 v[48:63], v[132:135], v[104:107], v[48:63]
  ds_read_b64_tr_b16 v[122:123], v160 offset:58368
  ds_read_b64_tr_b16 v[124:125], v161 offset:57344
  v_mfma_f32_32x32x16_bf16 v[64:79], v[128:131], v[108:111], v[64:79]
  ds_read_b64_tr_b16 v[126:127], v161 offset:58368
  ds_read_b128 v[100:103], v154 offset:32768
  v_mfma_f32_32x32x16_bf16 v[80:95], v[132:135], v[108:111], v[80:95]
  s_waitcnt lgkmcnt(6)
  v_mfma_f32_32x32x16_bf16 v[32:47], v[136:139], v[112:115], v[32:47]
  ds_read_b128 v[104:107], v147 offset:32768
  ds_read_b64_tr_b16 v[128:129], v160 offset:61440
  v_mfma_f32_16x16x32_bf16 v[184:187], v[24:27], v[136:139], v[184:187]
  v_mfma_f32_32x32x16_bf16 v[48:63], v[140:143], v[112:115], v[48:63]
  ds_read_b64_tr_b16 v[130:131], v160 offset:62464
  ds_read_b64_tr_b16 v[132:133], v161 offset:61440
  v_mfma_f32_32x32x16_bf16 v[64:79], v[136:139], v[116:119], v[64:79]
  ds_read_b64_tr_b16 v[134:135], v161 offset:62464
  ds_read_b128 v[108:111], v155 offset:32768
  v_mfma_f32_32x32x16_bf16 v[80:95], v[140:143], v[116:119], v[80:95]
  s_waitcnt lgkmcnt(0)
  s_barrier
  v_mfma_f32_32x32x16_bf16 v[32:47], v[120:123], v[96:99], v[32:47]
  ds_read_b128 v[112:115], v148 offset:0
  ds_read_b64_tr_b16 v[136:137], v162 offset:16384
  v_mfma_f32_16x16x32_bf16 v[184:187], v[24:27], v[120:123], v[184:187]
  v_mfma_f32_32x32x16_bf16 v[48:63], v[124:127], v[96:99], v[48:63]
  ds_read_b64_tr_b16 v[138:139], v162 offset:17408
  ds_read_b64_tr_b16 v[140:141], v163 offset:16384
  v_mfma_f32_32x32x16_bf16 v[64:79], v[120:123], v[100:103], v[64:79]
  ds_read_b64_tr_b16 v[142:143], v163 offset:17408
  ds_read_b128 v[116:119], v156 offset:0
  v_mfma_f32_32x32x16_bf16 v[80:95], v[124:127], v[100:103], v[80:95]
  s_waitcnt lgkmcnt(6)
  v_mfma_f32_32x32x16_bf16 v[32:47], v[128:131], v[104:107], v[32:47]
  ds_read_b128 v[96:99], v149 offset:0
  ds_read_b64_tr_b16 v[120:121], v162 offset:20480
  v_mfma_f32_16x16x32_bf16 v[184:187], v[24:27], v[128:131], v[184:187]
  v_mfma_f32_32x32x16_bf16 v[48:63], v[132:135], v[104:107], v[48:63]
  ds_read_b64_tr_b16 v[122:123], v162 offset:21504
  ds_read_b64_tr_b16 v[124:125], v163 offset:20480
  v_mfma_f32_32x32x16_bf16 v[64:79], v[128:131], v[108:111], v[64:79]
  ds_read_b64_tr_b16 v[126:127], v163 offset:21504
  ds_read_b128 v[100:103], v157 offset:0
  v_mfma_f32_32x32x16_bf16 v[80:95], v[132:135], v[108:111], v[80:95]
  s_waitcnt lgkmcnt(6)
  v_mfma_f32_32x32x16_bf16 v[32:47], v[136:139], v[112:115], v[32:47]
  ds_read_b128 v[104:107], v150 offset:0
  ds_read_b64_tr_b16 v[128:129], v162 offset:24576
  v_mfma_f32_16x16x32_bf16 v[184:187], v[24:27], v[136:139], v[184:187]
  v_mfma_f32_32x32x16_bf16 v[48:63], v[140:143], v[112:115], v[48:63]
  ds_read_b64_tr_b16 v[130:131], v162 offset:25600
  ds_read_b64_tr_b16 v[132:133], v163 offset:24576
  v_mfma_f32_32x32x16_bf16 v[64:79], v[136:139], v[116:119], v[64:79]
  ds_read_b64_tr_b16 v[134:135], v163 offset:25600
  ds_read_b128 v[108:111], v158 offset:0
  v_mfma_f32_32x32x16_bf16 v[80:95], v[140:143], v[116:119], v[80:95]
  s_waitcnt lgkmcnt(6)
  v_mfma_f32_32x32x16_bf16 v[32:47], v[120:123], v[96:99], v[32:47]
  ds_read_b128 v[112:115], v151 offset:0
  ds_read_b64_tr_b16 v[136:137], v162 offset:28672
  v_mfma_f32_16x16x32_bf16 v[184:187], v[24:27], v[120:123], v[184:187]
  v_mfma_f32_32x32x16_bf16 v[48:63], v[124:127], v[96:99], v[48:63]
  ds_read_b64_tr_b16 v[138:139], v162 offset:29696
  ds_read_b64_tr_b16 v[140:141], v163 offset:28672
  v_mfma_f32_32x32x16_bf16 v[64:79], v[120:123], v[100:103], v[64:79]
  ds_read_b64_tr_b16 v[142:143], v163 offset:29696
  ds_read_b128 v[116:119], v159 offset:0
  v_mfma_f32_32x32x16_bf16 v[80:95], v[124:127], v[100:103], v[80:95]
  s_waitcnt lgkmcnt(0)
  s_barrier
  v_mfma_f32_32x32x16_bf16 v[32:47], v[128:131], v[104:107], v[32:47]
  ds_read_b128 v[96:99], v148 offset:32768
  ds_read_b64_tr_b16 v[120:121], v162 offset:49152
  v_mfma_f32_16x16x32_bf16 v[184:187], v[24:27], v[128:131], v[184:187]
  v_mfma_f32_32x32x16_bf16 v[48:63], v[132:135], v[104:107], v[48:63]
  ds_read_b64_tr_b16 v[122:123], v162 offset:50176
  ds_read_b64_tr_b16 v[124:125], v163 offset:49152
  v_mfma_f32_32x32x16_bf16 v[64:79], v[128:131], v[108:111], v[64:79]
  ds_read_b64_tr_b16 v[126:127], v163 offset:50176
  ds_read_b128 v[100:103], v156 offset:32768
  v_mfma_f32_32x32x16_bf16 v[80:95], v[132:135], v[108:111], v[80:95]
  s_waitcnt lgkmcnt(6)
  v_mfma_f32_32x32x16_bf16 v[32:47], v[136:139], v[112:115], v[32:47]
  ds_read_b128 v[104:107], v149 offset:32768
  ds_read_b64_tr_b16 v[128:129], v162 offset:53248
  v_mfma_f32_16x16x32_bf16 v[184:187], v[24:27], v[136:139], v[184:187]
  v_mfma_f32_32x32x16_bf16 v[48:63], v[140:143], v[112:115], v[48:63]
  ds_read_b64_tr_b16 v[130:131], v162 offset:54272
  ds_read_b64_tr_b16 v[132:133], v163 offset:53248
  v_mfma_f32_32x32x16_bf16 v[64:79], v[136:139], v[116:119], v[64:79]
  ds_read_b64_tr_b16 v[134:135], v163 offset:54272
  ds_read_b128 v[108:111], v157 offset:32768
  v_mfma_f32_32x32x16_bf16 v[80:95], v[140:143], v[116:119], v[80:95]
  s_waitcnt lgkmcnt(6)
  v_mfma_f32_32x32x16_bf16 v[32:47], v[120:123], v[96:99], v[32:47]
  ds_read_b128 v[112:115], v150 offset:32768
  ds_read_b64_tr_b16 v[136:137], v162 offset:57344
  v_mfma_f32_16x16x32_bf16 v[184:187], v[24:27], v[120:123], v[184:187]
  v_mfma_f32_32x32x16_bf16 v[48:63], v[124:127], v[96:99], v[48:63]
  ds_read_b64_tr_b16 v[138:139], v162 offset:58368
  ds_read_b64_tr_b16 v[140:141], v163 offset:57344
  v_mfma_f32_32x32x16_bf16 v[64:79], v[120:123], v[100:103], v[64:79]
  ds_read_b64_tr_b16 v[142:143], v163 offset:58368
  ds_read_b128 v[116:119], v158 offset:32768
  v_mfma_f32_32x32x16_bf16 v[80:95], v[124:127], v[100:103], v[80:95]
  s_waitcnt lgkmcnt(6)
  v_mfma_f32_32x32x16_bf16 v[32:47], v[128:131], v[104:107], v[32:47]
  ds_read_b128 v[96:99], v151 offset:32768
  ds_read_b64_tr_b16 v[120:121], v162 offset:61440
  v_mfma_f32_16x16x32_bf16 v[184:187], v[24:27], v[128:131], v[184:187]
  v_mfma_f32_32x32x16_bf16 v[48:63], v[132:135], v[104:107], v[48:63]
  ds_read_b64_tr_b16 v[122:123], v162 offset:62464
  ds_read_b64_tr_b16 v[124:125], v163 offset:61440
  v_mfma_f32_32x32x16_bf16 v[64:79], v[128:131], v[108:111], v[64:79]
  ds_read_b64_tr_b16 v[126:127], v163 offset:62464
  ds_read_b128 v[100:103], v159 offset:32768
  v_mfma_f32_32x32x16_bf16 v[80:95], v[132:135], v[108:111], v[80:95]
  s_waitcnt lgkmcnt(0)
  s_barrier
  v_mfma_f32_32x32x16_bf16 v[32:47], v[136:139], v[112:115], v[32:47]
  ds_read_b128 v[104:107], v144 offset:0
  ds_read_b64_tr_b16 v[128:129], v160 offset:16384
  v_mfma_f32_16x16x32_bf16 v[184:187], v[24:27], v[136:139], v[184:187]
  v_mfma_f32_32x32x16_bf16 v[48:63], v[140:143], v[112:115], v[48:63]
  ds_read_b64_tr_b16 v[130:131], v160 offset:17408
  ds_read_b64_tr_b16 v[132:133], v161 offset:16384
  v_mfma_f32_32x32x16_bf16 v[64:79], v[136:139], v[116:119], v[64:79]
  ds_read_b64_tr_b16 v[134:135], v161 offset:17408
  ds_read_b128 v[108:111], v152 offset:0
  v_mfma_f32_32x32x16_bf16 v[80:95], v[140:143], v[116:119], v[80:95]
  s_waitcnt lgkmcnt(6)
  v_mfma_f32_32x32x16_bf16 v[32:47], v[120:123], v[96:99], v[32:47]
  ds_read_b128 v[112:115], v145 offset:0
  ds_read_b64_tr_b16 v[136:137], v160 offset:20480
  v_mfma_f32_16x16x32_bf16 v[184:187], v[24:27], v[120:123], v[184:187]
  v_mfma_f32_32x32x16_bf16 v[48:63], v[124:127], v[96:99], v[48:63]
  ds_read_b64_tr_b16 v[138:139], v160 offset:21504
  ds_read_b64_tr_b16 v[140:141], v161 offset:20480
  v_mfma_f32_32x32x16_bf16 v[64:79], v[120:123], v[100:103], v[64:79]
  ds_read_b64_tr_b16 v[142:143], v161 offset:21504
  ds_read_b128 v[116:119], v153 offset:0
  v_mfma_f32_32x32x16_bf16 v[80:95], v[124:127], v[100:103], v[80:95]
  s_waitcnt lgkmcnt(6)
  v_mfma_f32_32x32x16_bf16 v[32:47], v[128:131], v[104:107], v[32:47]
  ds_read_b128 v[96:99], v146 offset:0
  ds_read_b64_tr_b16 v[120:121], v160 offset:24576
  v_mfma_f32_16x16x32_bf16 v[184:187], v[24:27], v[128:131], v[184:187]
  v_mfma_f32_32x32x16_bf16 v[48:63], v[132:135], v[104:107], v[48:63]
  ds_read_b64_tr_b16 v[122:123], v160 offset:25600
  ds_read_b64_tr_b16 v[124:125], v161 offset:24576
  v_mfma_f32_32x32x16_bf16 v[64:79], v[128:131], v[108:111], v[64:79]
  ds_read_b64_tr_b16 v[126:127], v161 offset:25600
  ds_read_b128 v[100:103], v154 offset:0
  v_mfma_f32_32x32x16_bf16 v[80:95], v[132:135], v[108:111], v[80:95]
  s_waitcnt lgkmcnt(6)
  v_mfma_f32_32x32x16_bf16 v[32:47], v[136:139], v[112:115], v[32:47]
  ds_read_b128 v[104:107], v147 offset:0
  ds_read_b64_tr_b16 v[128:129], v160 offset:28672
  v_mfma_f32_16x16x32_bf16 v[184:187], v[24:27], v[136:139], v[184:187]
  v_mfma_f32_32x32x16_bf16 v[48:63], v[140:143], v[112:115], v[48:63]
  ds_read_b64_tr_b16 v[130:131], v160 offset:29696
  ds_read_b64_tr_b16 v[132:133], v161 offset:28672
  v_mfma_f32_32x32x16_bf16 v[64:79], v[136:139], v[116:119], v[64:79]
  ds_read_b64_tr_b16 v[134:135], v161 offset:29696
  ds_read_b128 v[108:111], v155 offset:0
  v_mfma_f32_32x32x16_bf16 v[80:95], v[140:143], v[116:119], v[80:95]
  s_waitcnt lgkmcnt(0)
  s_barrier
  v_mfma_f32_32x32x16_bf16 v[32:47], v[120:123], v[96:99], v[32:47]
  ds_read_b128 v[112:115], v144 offset:32768
  ds_read_b64_tr_b16 v[136:137], v160 offset:49152
  v_mfma_f32_16x16x32_bf16 v[184:187], v[24:27], v[120:123], v[184:187]
  v_mfma_f32_32x32x16_bf16 v[48:63], v[124:127], v[96:99], v[48:63]
  ds_read_b64_tr_b16 v[138:139], v160 offset:50176
  ds_read_b64_tr_b16 v[140:141], v161 offset:49152
  v_mfma_f32_32x32x16_bf16 v[64:79], v[120:123], v[100:103], v[64:79]
  ds_read_b64_tr_b16 v[142:143], v161 offset:50176
  ds_read_b128 v[116:119], v152 offset:32768
  v_mfma_f32_32x32x16_bf16 v[80:95], v[124:127], v[100:103], v[80:95]
  s_waitcnt lgkmcnt(6)
  v_mfma_f32_32x32x16_bf16 v[32:47], v[128:131], v[104:107], v[32:47]
  ds_read_b128 v[96:99], v145 offset:32768
  ds_read_b64_tr_b16 v[120:121], v160 offset:53248
  v_mfma_f32_16x16x32_bf16 v[184:187], v[24:27], v[128:131], v[184:187]
  v_mfma_f32_32x32x16_bf16 v[48:63], v[132:135], v[104:107], v[48:63]
  ds_read_b64_tr_b16 v[122:123], v160 offset:54272
  ds_read_b64_tr_b16 v[124:125], v161 offset:53248
  v_mfma_f32_32x32x16_bf16 v[64:79], v[128:131], v[108:111], v[64:79]
  ds_read_b64_tr_b16 v[126:127], v161 offset:54272
  ds_read_b128 v[100:103], v153 offset:32768
  v_mfma_f32_32x32x16_bf16 v[80:95], v[132:135], v[108:111], v[80:95]
  s_waitcnt lgkmcnt(6)
  v_mfma_f32_32x32x16_bf16 v[32:47], v[136:139], v[112:115], v[32:47]
  ds_read_b128 v[104:107], v146 offset:32768
  ds_read_b64_tr_b16 v[128:129], v160 offset:57344
  v_mfma_f32_16x16x32_bf16 v[184:187], v[24:27], v[136:139], v[184:187]
  v_mfma_f32_32x32x16_bf16 v[48:63], v[140:143], v[112:115], v[48:63]
  ds_read_b64_tr_b16 v[130:131], v160 offset:58368
  ds_read_b64_tr_b16 v[132:133], v161 offset:57344
  v_mfma_f32_32x32x16_bf16 v[64:79], v[136:139], v[116:119], v[64:79]
  ds_read_b64_tr_b16 v[134:135], v161 offset:58368
  ds_read_b128 v[108:111], v154 offset:32768
  v_mfma_f32_32x32x16_bf16 v[80:95], v[140:143], v[116:119], v[80:95]
  s_waitcnt lgkmcnt(6)
  v_mfma_f32_32x32x16_bf16 v[32:47], v[120:123], v[96:99], v[32:47]
  ds_read_b128 v[112:115], v147 offset:32768
  ds_read_b64_tr_b16 v[136:137], v160 offset:61440
  v_mfma_f32_16x16x32_bf16 v[184:187], v[24:27], v[120:123], v[184:187]
  v_mfma_f32_32x32x16_bf16 v[48:63], v[124:127], v[96:99], v[48:63]
  ds_read_b64_tr_b16 v[138:139], v160 offset:62464
  ds_read_b64_tr_b16 v[140:141], v161 offset:61440
  v_mfma_f32_32x32x16_bf16 v[64:79], v[120:123], v[100:103], v[64:79]
  ds_read_b64_tr_b16 v[142:143], v161 offset:62464
  ds_read_b128 v[116:119], v155 offset:32768
  v_mfma_f32_32x32x16_bf16 v[80:95], v[124:127], v[100:103], v[80:95]
  s_waitcnt lgkmcnt(0)
  s_barrier
  v_mfma_f32_32x32x16_bf16 v[32:47], v[128:131], v[104:107], v[32:47]
  ds_read_b128 v[96:99], v148 offset:0
  ds_read_b64_tr_b16 v[120:121], v162 offset:16384
  v_mfma_f32_16x16x32_bf16 v[184:187], v[24:27], v[128:131], v[184:187]
  v_mfma_f32_32x32x16_bf16 v[48:63], v[132:135], v[104:107], v[48:63]
  ds_read_b64_tr_b16 v[122:123], v162 offset:17408
  ds_read_b64_tr_b16 v[124:125], v163 offset:16384
  v_mfma_f32_32x32x16_bf16 v[64:79], v[128:131], v[108:111], v[64:79]
  ds_read_b64_tr_b16 v[126:127], v163 offset:17408
  ds_read_b128 v[100:103], v156 offset:0
  v_mfma_f32_32x32x16_bf16 v[80:95], v[132:135], v[108:111], v[80:95]
  s_waitcnt lgkmcnt(6)
  v_mfma_f32_32x32x16_bf16 v[32:47], v[136:139], v[112:115], v[32:47]
  ds_read_b128 v[104:107], v149 offset:0
  ds_read_b64_tr_b16 v[128:129], v162 offset:20480
  v_mfma_f32_16x16x32_bf16 v[184:187], v[24:27], v[136:139], v[184:187]
  v_mfma_f32_32x32x16_bf16 v[48:63], v[140:143], v[112:115], v[48:63]
  ds_read_b64_tr_b16 v[130:131], v162 offset:21504
  ds_read_b64_tr_b16 v[132:133], v163 offset:20480
  v_mfma_f32_32x32x16_bf16 v[64:79], v[136:139], v[116:119], v[64:79]
  ds_read_b64_tr_b16 v[134:135], v163 offset:21504
  ds_read_b128 v[108:111], v157 offset:0
  v_mfma_f32_32x32x16_bf16 v[80:95], v[140:143], v[116:119], v[80:95]
  s_waitcnt lgkmcnt(6)
  v_mfma_f32_32x32x16_bf16 v[32:47], v[120:123], v[96:99], v[32:47]
  ds_read_b128 v[112:115], v150 offset:0
  ds_read_b64_tr_b16 v[136:137], v162 offset:24576
  v_mfma_f32_16x16x32_bf16 v[184:187], v[24:27], v[120:123], v[184:187]
  v_mfma_f32_32x32x16_bf16 v[48:63], v[124:127], v[96:99], v[48:63]
  ds_read_b64_tr_b16 v[138:139], v162 offset:25600
  ds_read_b64_tr_b16 v[140:141], v163 offset:24576
  v_mfma_f32_32x32x16_bf16 v[64:79], v[120:123], v[100:103], v[64:79]
  ds_read_b64_tr_b16 v[142:143], v163 offset:25600
  ds_read_b128 v[116:119], v158 offset:0
  v_mfma_f32_32x32x16_bf16 v[80:95], v[124:127], v[100:103], v[80:95]
  s_waitcnt lgkmcnt(6)
  v_mfma_f32_32x32x16_bf16 v[32:47], v[128:131], v[104:107], v[32:47]
  ds_read_b128 v[96:99], v151 offset:0
  ds_read_b64_tr_b16 v[120:121], v162 offset:28672
  v_mfma_f32_16x16x32_bf16 v[184:187], v[24:27], v[128:131], v[184:187]
  v_mfma_f32_32x32x16_bf16 v[48:63], v[132:135], v[104:107], v[48:63]
  ds_read_b64_tr_b16 v[122:123], v162 offset:29696
  ds_read_b64_tr_b16 v[124:125], v163 offset:28672
  v_mfma_f32_32x32x16_bf16 v[64:79], v[128:131], v[108:111], v[64:79]
  ds_read_b64_tr_b16 v[126:127], v163 offset:29696
  ds_read_b128 v[100:103], v159 offset:0
  v_mfma_f32_32x32x16_bf16 v[80:95], v[132:135], v[108:111], v[80:95]
  s_waitcnt lgkmcnt(0)
  s_barrier
  v_mfma_f32_32x32x16_bf16 v[32:47], v[136:139], v[112:115], v[32:47]
  ds_read_b128 v[104:107], v148 offset:32768
  ds_read_b64_tr_b16 v[128:129], v162 offset:49152
  v_mfma_f32_16x16x32_bf16 v[184:187], v[24:27], v[136:139], v[184:187]
  v_mfma_f32_32x32x16_bf16 v[48:63], v[140:143], v[112:115], v[48:63]
  ds_read_b64_tr_b16 v[130:131], v162 offset:50176
  ds_read_b64_tr_b16 v[132:133], v163 offset:49152
  v_mfma_f32_32x32x16_bf16 v[64:79], v[136:139], v[116:119], v[64:79]
  ds_read_b64_tr_b16 v[134:135], v163 offset:50176
  ds_read_b128 v[108:111], v156 offset:32768
  v_mfma_f32_32x32x16_bf16 v[80:95], v[140:143], v[116:119], v[80:95]
  s_waitcnt lgkmcnt(6)
  v_mfma_f32_32x32x16_bf16 v[32:47], v[120:123], v[96:99], v[32:47]
  ds_read_b128 v[112:115], v149 offset:32768
  ds_read_b64_tr_b16 v[136:137], v162 offset:53248
  v_mfma_f32_16x16x32_bf16 v[184:187], v[24:27], v[120:123], v[184:187]
  v_mfma_f32_32x32x16_bf16 v[48:63], v[124:127], v[96:99], v[48:63]
  ds_read_b64_tr_b16 v[138:139], v162 offset:54272
  ds_read_b64_tr_b16 v[140:141], v163 offset:53248
  v_mfma_f32_32x32x16_bf16 v[64:79], v[120:123], v[100:103], v[64:79]
  ds_read_b64_tr_b16 v[142:143], v163 offset:54272
  ds_read_b128 v[116:119], v157 offset:32768
  v_mfma_f32_32x32x16_bf16 v[80:95], v[124:127], v[100:103], v[80:95]
  s_waitcnt lgkmcnt(6)
  v_mfma_f32_32x32x16_bf16 v[32:47], v[128:131], v[104:107], v[32:47]
  ds_read_b128 v[96:99], v150 offset:32768
  ds_read_b64_tr_b16 v[120:121], v162 offset:57344
  v_mfma_f32_16x16x32_bf16 v[184:187], v[24:27], v[128:131], v[184:187]
  v_mfma_f32_32x32x16_bf16 v[48:63], v[132:135], v[104:107], v[48:63]
  ds_read_b64_tr_b16 v[122:123], v162 offset:58368
  ds_read_b64_tr_b16 v[124:125], v163 offset:57344
  v_mfma_f32_32x32x16_bf16 v[64:79], v[128:131], v[108:111], v[64:79]
  ds_read_b64_tr_b16 v[126:127], v163 offset:58368
  ds_read_b128 v[100:103], v158 offset:32768
  v_mfma_f32_32x32x16_bf16 v[80:95], v[132:135], v[108:111], v[80:95]
  s_waitcnt lgkmcnt(6)
  v_mfma_f32_32x32x16_bf16 v[32:47], v[136:139], v[112:115], v[32:47]
  ds_read_b128 v[104:107], v151 offset:32768
  ds_read_b64_tr_b16 v[128:129], v162 offset:61440
  v_mfma_f32_16x16x32_bf16 v[184:187], v[24:27], v[136:139], v[184:187]
  v_mfma_f32_32x32x16_bf16 v[48:63], v[140:143], v[112:115], v[48:63]
  ds_read_b64_tr_b16 v[130:131], v162 offset:62464
  ds_read_b64_tr_b16 v[132:133], v163 offset:61440
  v_mfma_f32_32x32x16_bf16 v[64:79], v[136:139], v[116:119], v[64:79]
  ds_read_b64_tr_b16 v[134:135], v163 offset:62464
  ds_read_b128 v[108:111], v159 offset:32768
  v_mfma_f32_32x32x16_bf16 v[80:95], v[140:143], v[116:119], v[80:95]
  s_waitcnt lgkmcnt(6)
  v_mfma_f32_32x32x16_bf16 v[32:47], v[120:123], v[96:99], v[32:47]
  v_mfma_f32_16x16x32_bf16 v[184:187], v[24:27], v[120:123], v[184:187]
  v_mfma_f32_32x32x16_bf16 v[48:63], v[124:127], v[96:99], v[48:63]
  v_mfma_f32_32x32x16_bf16 v[64:79], v[120:123], v[100:103], v[64:79]
  v_mfma_f32_32x32x16_bf16 v[80:95], v[124:127], v[100:103], v[80:95]
  s_waitcnt lgkmcnt(0)
  v_mfma_f32_32x32x16_bf16 v[32:47], v[128:131], v[104:107], v[32:47]
  v_mfma_f32_16x16x32_bf16 v[184:187], v[24:27], v[128:131], v[184:187]
  v_mfma_f32_32x32x16_bf16 v[48:63], v[132:135], v[104:107], v[48:63]
  v_mfma_f32_32x32x16_bf16 v[64:79], v[128:131], v[108:111], v[64:79]
  v_mfma_f32_32x32x16_bf16 v[80:95], v[132:135], v[108:111], v[80:95]
  s_nop 15
  s_nop 7
  v_lshlrev_b32 v2, 4, v1
  s_lshl_b32 s6, s37, 13
  v_add_u32 v2, s6, v2
  ds_write_b128 v2, v[64:67] offset:4096
  ds_write_b128 v2, v[68:71] offset:5120
  ds_write_b128 v2, v[72:75] offset:6144
  ds_write_b128 v2, v[76:79] offset:7168
  ds_write_b128 v2, v[80:83] offset:8192
  ds_write_b128 v2, v[84:87] offset:9216
  ds_write_b128 v2, v[88:91] offset:10240
  ds_write_b128 v2, v[92:95] offset:11264
  s_lshl_b32 s6, s5, 8
  s_lshl_b32 s7, s4, 7
  s_add_u32 s6, s6, s7
  v_lshlrev_b32 v6, 2, v1
  v_add_u32 v6, s6, v6
  s_mov_b64 exec, 0xffff
  ds_write_b32 v6, v184 offset:1024
  ds_write_b32 v6, v185 offset:1088
  s_mov_b64 exec, -1
  s_waitcnt lgkmcnt(0)
  s_barrier
  s_waitcnt vmcnt(0)
  v_add_f32 v188, v188, v190
  v_add_f32 v189, v189, v191
  v_add_f32 v188, v188, v192
  v_add_f32 v189, v189, v193
  v_add_f32 v188, v188, v194
  v_add_f32 v189, v189, v195
  v_add_f32 v188, v188, v196
  v_add_f32 v189, v189, v197
  v_add_f32 v188, v188, v198
  v_add_f32 v189, v189, v199
  v_add_f32 v188, v188, v200
  v_add_f32 v189, v189, v201
  v_add_f32 v188, v188, v202
  v_add_f32 v189, v189, v203
  v_mov_b32 v190, v188
  v_mov_b32 v191, v189
  s_nop 1
  v_permlane32_swap_b32 v188, v190
  v_permlane32_swap_b32 v189, v191
  s_nop 1
  v_add_f32 v188, v188, v190
  v_add_f32 v189, v189, v191
  v_mul_f32 v188, 0x3b000000, v188
  v_mul_f32 v189, 0x3b000000, v189
  v_fma_f32 v189, -v188, v188, v189
  v_max_f32 v189, 0, v189
  v_cvt_pk_bf16_f32 v188, v188, v188
  v_lshlrev_b32 v188, 16, v188
  v_cvt_pk_bf16_f32 v189, v189, v189
  v_lshlrev_b32 v189, 16, v189
  v_add_f32 v189, 0x3727c5ac, v189
  v_cvt_pk_bf16_f32 v189, v189, v189
  v_lshlrev_b32 v189, 16, v189
  v_sqrt_f32 v189, v189
  s_nop 0
  v_cvt_pk_bf16_f32 v189, v189, v189
  v_lshlrev_b32 v189, 16, v189
  v_rcp_f32 v8, v189
  s_nop 0
  v_mul_f32 v10, v188, v8
  v_lshrrev_b32 v3, 5, v1
  v_lshlrev_b32 v5, 4, v3
  s_lshl_b32 s6, s5, 8
  v_add_u32 v5, s6, v5
  s_xor_b32 s6, s4, 0
  s_lshl_b32 s6, s6, 7
  v_add_u32 v6, s6, v5
  ds_read_b128 v[96:99], v6 offset:1024
  ds_read_b128 v[100:103], v6 offset:1056
  ds_read_b128 v[104:107], v6 offset:1088
  ds_read_b128 v[108:111], v6 offset:1120
  s_xor_b32 s6, s4, 1
  s_lshl_b32 s6, s6, 7
  v_add_u32 v6, s6, v5
  ds_read_b128 v[112:115], v6 offset:1024
  ds_read_b128 v[116:119], v6 offset:1056
  ds_read_b128 v[120:123], v6 offset:1088
  ds_read_b128 v[124:127], v6 offset:1120
  s_waitcnt lgkmcnt(0)
  s_lshl_b32 s34, s31, 2
  s_lshl_b32 s6, s4, 1
  s_add_u32 s34, s34, s6
  s_mul_i32 s34, s34, 112
  s_lshl_b32 s6, s32, 3
  s_add_u32 s34, s34, s6
  s_lshl_b32 s6, s5, 2
  s_add_u32 s34, s34, s6
  s_lshl_b32 s34, s34, 10
  v_lshlrev_b32 v6, 4, v1
  s_xor_b32 s35, s5, 0
  s_mul_i32 s35, s35, 114688
  s_add_u32 s35, s35, s34
  s_xor_b32 s36, s4, 0
  s_lshl_b32 s36, s36, 11
  s_add_u32 s36, s36, s35
  v_pk_mul_f32 v[132:133], v[32:33], v[8:9] op_sel_hi:[1,0]
  v_pk_mul_f32 v[134:135], v[34:35], v[8:9] op_sel_hi:[1,0]
  v_pk_mul_f32 v[136:137], v[36:37], v[8:9] op_sel_hi:[1,0]
  v_pk_mul_f32 v[138:139], v[38:39], v[8:9] op_sel_hi:[1,0]
  v_pk_fma_f32 v[132:133], v[96:97], v[10:11], v[132:133] op_sel_hi:[1,0,1] neg_lo:[0,1,0] neg_hi:[0,1,0]
  v_pk_fma_f32 v[134:135], v[98:99], v[10:11], v[134:135] op_sel_hi:[1,0,1] neg_lo:[0,1,0] neg_hi:[0,1,0]
  v_pk_fma_f32 v[136:137], v[100:101], v[10:11], v[136:137] op_sel_hi:[1,0,1] neg_lo:[0,1,0] neg_hi:[0,1,0]
  v_pk_fma_f32 v[138:139], v[102:103], v[10:11], v[138:139] op_sel_hi:[1,0,1] neg_lo:[0,1,0] neg_hi:[0,1,0]
  v_cvt_pk_bf16_f32 v148, v132, v133
  v_cvt_pk_bf16_f32 v149, v134, v135
  v_cvt_pk_bf16_f32 v150, v136, v137
  v_cvt_pk_bf16_f32 v151, v138, v139
  v_lshlrev_b32 v132, 16, v148
  v_and_b32 v133, 0xffff0000, v148
  v_lshlrev_b32 v134, 16, v149
  v_and_b32 v135, 0xffff0000, v149
  v_lshlrev_b32 v136, 16, v150
  v_and_b32 v137, 0xffff0000, v150
  v_lshlrev_b32 v138, 16, v151
  v_and_b32 v139, 0xffff0000, v151
  v_pk_mul_f32 v[140:141], v[132:133], s[54:55]
  v_pk_mul_f32 v[142:143], v[134:135], s[54:55]
  v_pk_mul_f32 v[144:145], v[136:137], s[54:55]
  v_pk_mul_f32 v[146:147], v[138:139], s[54:55]
  v_exp_f32 v140, v140
  v_exp_f32 v141, v141
  v_exp_f32 v142, v142
  v_exp_f32 v143, v143
  v_exp_f32 v144, v144
  v_exp_f32 v145, v145
  v_exp_f32 v146, v146
  v_exp_f32 v147, v147
  v_pk_add_f32 v[140:141], v[140:141], 1.0 op_sel_hi:[1,0]
  v_pk_add_f32 v[142:143], v[142:143], 1.0 op_sel_hi:[1,0]
  v_pk_add_f32 v[144:145], v[144:145], 1.0 op_sel_hi:[1,0]
  v_pk_add_f32 v[146:147], v[146:147], 1.0 op_sel_hi:[1,0]
  v_rcp_f32 v140, v140
  v_rcp_f32 v141, v141
  v_rcp_f32 v142, v142
  v_rcp_f32 v143, v143
  v_rcp_f32 v144, v144
  v_rcp_f32 v145, v145
  v_rcp_f32 v146, v146
  v_rcp_f32 v147, v147
  s_nop 0
  v_pk_mul_f32 v[132:133], v[132:133], v[140:141]
  v_pk_mul_f32 v[134:135], v[134:135], v[142:143]
  v_pk_mul_f32 v[136:137], v[136:137], v[144:145]
  v_pk_mul_f32 v[138:139], v[138:139], v[146:147]
  v_cvt_pk_bf16_f32 v128, v132, v133
  v_cvt_pk_bf16_f32 v129, v134, v135
  v_cvt_pk_bf16_f32 v130, v136, v137
  v_cvt_pk_bf16_f32 v131, v138, v139
  s_add_u32 s7, s36, 0
  buffer_store_dwordx4 v[128:131], v6, s[16:19], s7 offen
  v_pk_mul_f32 v[132:133], v[40:41], v[8:9] op_sel_hi:[1,0]
  v_pk_mul_f32 v[134:135], v[42:43], v[8:9] op_sel_hi:[1,0]
  v_pk_mul_f32 v[136:137], v[44:45], v[8:9] op_sel_hi:[1,0]
  v_pk_mul_f32 v[138:139], v[46:47], v[8:9] op_sel_hi:[1,0]
  v_pk_fma_f32 v[132:133], v[104:105], v[10:11], v[132:133] op_sel_hi:[1,0,1] neg_lo:[0,1,0] neg_hi:[0,1,0]
  v_pk_fma_f32 v[134:135], v[106:107], v[10:11], v[134:135] op_sel_hi:[1,0,1] neg_lo:[0,1,0] neg_hi:[0,1,0]
  v_pk_fma_f32 v[136:137], v[108:109], v[10:11], v[136:137] op_sel_hi:[1,0,1] neg_lo:[0,1,0] neg_hi:[0,1,0]
  v_pk_fma_f32 v[138:139], v[110:111], v[10:11], v[138:139] op_sel_hi:[1,0,1] neg_lo:[0,1,0] neg_hi:[0,1,0]
  v_cvt_pk_bf16_f32 v148, v132, v133
  v_cvt_pk_bf16_f32 v149, v134, v135
  v_cvt_pk_bf16_f32 v150, v136, v137
  v_cvt_pk_bf16_f32 v151, v138, v139
  v_lshlrev_b32 v132, 16, v148
  v_and_b32 v133, 0xffff0000, v148
  v_lshlrev_b32 v134, 16, v149
  v_and_b32 v135, 0xffff0000, v149
  v_lshlrev_b32 v136, 16, v150
  v_and_b32 v137, 0xffff0000, v150
  v_lshlrev_b32 v138, 16, v151
  v_and_b32 v139, 0xffff0000, v151
  v_pk_mul_f32 v[140:141], v[132:133], s[54:55]
  v_pk_mul_f32 v[142:143], v[134:135], s[54:55]
  v_pk_mul_f32 v[144:145], v[136:137], s[54:55]
  v_pk_mul_f32 v[146:147], v[138:139], s[54:55]
  v_exp_f32 v140, v140
  v_exp_f32 v141, v141
  v_exp_f32 v142, v142
  v_exp_f32 v143, v143
  v_exp_f32 v144, v144
  v_exp_f32 v145, v145
  v_exp_f32 v146, v146
  v_exp_f32 v147, v147
  v_pk_add_f32 v[140:141], v[140:141], 1.0 op_sel_hi:[1,0]
  v_pk_add_f32 v[142:143], v[142:143], 1.0 op_sel_hi:[1,0]
  v_pk_add_f32 v[144:145], v[144:145], 1.0 op_sel_hi:[1,0]
  v_pk_add_f32 v[146:147], v[146:147], 1.0 op_sel_hi:[1,0]
  v_rcp_f32 v140, v140
  v_rcp_f32 v141, v141
  v_rcp_f32 v142, v142
  v_rcp_f32 v143, v143
  v_rcp_f32 v144, v144
  v_rcp_f32 v145, v145
  v_rcp_f32 v146, v146
  v_rcp_f32 v147, v147
  s_nop 0
  v_pk_mul_f32 v[132:133], v[132:133], v[140:141]
  v_pk_mul_f32 v[134:135], v[134:135], v[142:143]
  v_pk_mul_f32 v[136:137], v[136:137], v[144:145]
  v_pk_mul_f32 v[138:139], v[138:139], v[146:147]
  v_cvt_pk_bf16_f32 v128, v132, v133
  v_cvt_pk_bf16_f32 v129, v134, v135
  v_cvt_pk_bf16_f32 v130, v136, v137
  v_cvt_pk_bf16_f32 v131, v138, v139
  s_add_u32 s7, s36, 1024
  buffer_store_dwordx4 v[128:131], v6, s[16:19], s7 offen
  s_xor_b32 s36, s4, 1
  s_lshl_b32 s36, s36, 11
  s_add_u32 s36, s36, s35
  v_pk_mul_f32 v[132:133], v[48:49], v[8:9] op_sel_hi:[1,0]
  v_pk_mul_f32 v[134:135], v[50:51], v[8:9] op_sel_hi:[1,0]
  v_pk_mul_f32 v[136:137], v[52:53], v[8:9] op_sel_hi:[1,0]
  v_pk_mul_f32 v[138:139], v[54:55], v[8:9] op_sel_hi:[1,0]
  v_pk_fma_f32 v[132:133], v[112:113], v[10:11], v[132:133] op_sel_hi:[1,0,1] neg_lo:[0,1,0] neg_hi:[0,1,0]
  v_pk_fma_f32 v[134:135], v[114:115], v[10:11], v[134:135] op_sel_hi:[1,0,1] neg_lo:[0,1,0] neg_hi:[0,1,0]
  v_pk_fma_f32 v[136:137], v[116:117], v[10:11], v[136:137] op_sel_hi:[1,0,1] neg_lo:[0,1,0] neg_hi:[0,1,0]
  v_pk_fma_f32 v[138:139], v[118:119], v[10:11], v[138:139] op_sel_hi:[1,0,1] neg_lo:[0,1,0] neg_hi:[0,1,0]
  v_cvt_pk_bf16_f32 v148, v132, v133
  v_cvt_pk_bf16_f32 v149, v134, v135
  v_cvt_pk_bf16_f32 v150, v136, v137
  v_cvt_pk_bf16_f32 v151, v138, v139
  v_lshlrev_b32 v132, 16, v148
  v_and_b32 v133, 0xffff0000, v148
  v_lshlrev_b32 v134, 16, v149
  v_and_b32 v135, 0xffff0000, v149
  v_lshlrev_b32 v136, 16, v150
  v_and_b32 v137, 0xffff0000, v150
  v_lshlrev_b32 v138, 16, v151
  v_and_b32 v139, 0xffff0000, v151
  v_pk_mul_f32 v[140:141], v[132:133], s[54:55]
  v_pk_mul_f32 v[142:143], v[134:135], s[54:55]
  v_pk_mul_f32 v[144:145], v[136:137], s[54:55]
  v_pk_mul_f32 v[146:147], v[138:139], s[54:55]
  v_exp_f32 v140, v140
  v_exp_f32 v141, v141
  v_exp_f32 v142, v142
  v_exp_f32 v143, v143
  v_exp_f32 v144, v144
  v_exp_f32 v145, v145
  v_exp_f32 v146, v146
  v_exp_f32 v147, v147
  v_pk_add_f32 v[140:141], v[140:141], 1.0 op_sel_hi:[1,0]
  v_pk_add_f32 v[142:143], v[142:143], 1.0 op_sel_hi:[1,0]
  v_pk_add_f32 v[144:145], v[144:145], 1.0 op_sel_hi:[1,0]
  v_pk_add_f32 v[146:147], v[146:147], 1.0 op_sel_hi:[1,0]
  v_rcp_f32 v140, v140
  v_rcp_f32 v141, v141
  v_rcp_f32 v142, v142
  v_rcp_f32 v143, v143
  v_rcp_f32 v144, v144
  v_rcp_f32 v145, v145
  v_rcp_f32 v146, v146
  v_rcp_f32 v147, v147
  s_nop 0
  v_pk_mul_f32 v[132:133], v[132:133], v[140:141]
  v_pk_mul_f32 v[134:135], v[134:135], v[142:143]
  v_pk_mul_f32 v[136:137], v[136:137], v[144:145]
  v_pk_mul_f32 v[138:139], v[138:139], v[146:147]
  v_cvt_pk_bf16_f32 v128, v132, v133
  v_cvt_pk_bf16_f32 v129, v134, v135
  v_cvt_pk_bf16_f32 v130, v136, v137
  v_cvt_pk_bf16_f32 v131, v138, v139
  s_add_u32 s7, s36, 0
  buffer_store_dwordx4 v[128:131], v6, s[16:19], s7 offen
  v_pk_mul_f32 v[132:133], v[56:57], v[8:9] op_sel_hi:[1,0]
  v_pk_mul_f32 v[134:135], v[58:59], v[8:9] op_sel_hi:[1,0]
  v_pk_mul_f32 v[136:137], v[60:61], v[8:9] op_sel_hi:[1,0]
  v_pk_mul_f32 v[138:139], v[62:63], v[8:9] op_sel_hi:[1,0]
  v_pk_fma_f32 v[132:133], v[120:121], v[10:11], v[132:133] op_sel_hi:[1,0,1] neg_lo:[0,1,0] neg_hi:[0,1,0]
  v_pk_fma_f32 v[134:135], v[122:123], v[10:11], v[134:135] op_sel_hi:[1,0,1] neg_lo:[0,1,0] neg_hi:[0,1,0]
  v_pk_fma_f32 v[136:137], v[124:125], v[10:11], v[136:137] op_sel_hi:[1,0,1] neg_lo:[0,1,0] neg_hi:[0,1,0]
  v_pk_fma_f32 v[138:139], v[126:127], v[10:11], v[138:139] op_sel_hi:[1,0,1] neg_lo:[0,1,0] neg_hi:[0,1,0]
  v_cvt_pk_bf16_f32 v148, v132, v133
  v_cvt_pk_bf16_f32 v149, v134, v135
  v_cvt_pk_bf16_f32 v150, v136, v137
  v_cvt_pk_bf16_f32 v151, v138, v139
  v_lshlrev_b32 v132, 16, v148
  v_and_b32 v133, 0xffff0000, v148
  v_lshlrev_b32 v134, 16, v149
  v_and_b32 v135, 0xffff0000, v149
  v_lshlrev_b32 v136, 16, v150
  v_and_b32 v137, 0xffff0000, v150
  v_lshlrev_b32 v138, 16, v151
  v_and_b32 v139, 0xffff0000, v151
  v_pk_mul_f32 v[140:141], v[132:133], s[54:55]
  v_pk_mul_f32 v[142:143], v[134:135], s[54:55]
  v_pk_mul_f32 v[144:145], v[136:137], s[54:55]
  v_pk_mul_f32 v[146:147], v[138:139], s[54:55]
  v_exp_f32 v140, v140
  v_exp_f32 v141, v141
  v_exp_f32 v142, v142
  v_exp_f32 v143, v143
  v_exp_f32 v144, v144
  v_exp_f32 v145, v145
  v_exp_f32 v146, v146
  v_exp_f32 v147, v147
  v_pk_add_f32 v[140:141], v[140:141], 1.0 op_sel_hi:[1,0]
  v_pk_add_f32 v[142:143], v[142:143], 1.0 op_sel_hi:[1,0]
  v_pk_add_f32 v[144:145], v[144:145], 1.0 op_sel_hi:[1,0]
  v_pk_add_f32 v[146:147], v[146:147], 1.0 op_sel_hi:[1,0]
  v_rcp_f32 v140, v140
  v_rcp_f32 v141, v141
  v_rcp_f32 v142, v142
  v_rcp_f32 v143, v143
  v_rcp_f32 v144, v144
  v_rcp_f32 v145, v145
  v_rcp_f32 v146, v146
  v_rcp_f32 v147, v147
  s_nop 0
  v_pk_mul_f32 v[132:133], v[132:133], v[140:141]
  v_pk_mul_f32 v[134:135], v[134:135], v[142:143]
  v_pk_mul_f32 v[136:137], v[136:137], v[144:145]
  v_pk_mul_f32 v[138:139], v[138:139], v[146:147]
  v_cvt_pk_bf16_f32 v128, v132, v133
  v_cvt_pk_bf16_f32 v129, v134, v135
  v_cvt_pk_bf16_f32 v130, v136, v137
  v_cvt_pk_bf16_f32 v131, v138, v139
  s_add_u32 s7, s36, 1024
  buffer_store_dwordx4 v[128:131], v6, s[16:19], s7 offen
  s_endpgm
P3_END:
  s_endpgm
.globl p4_kernel
.p2align 8
.type p4_kernel,@function
p4_kernel:
  s_cmp_ge_u32 s2, 256
  s_cbranch_scc1 P4_END
  s_load_dwordx2 s[40:41], s[0:1], 48
  s_load_dwordx2 s[50:51], s[0:1], 64
  v_and_b32 v1, 63, v0
  v_lshrrev_b32 v2, 6, v0
  s_nop 0
  v_readfirstlane_b32 s3, v2
  s_and_b32 s6, s2, 7
  s_lshr_b32 s7, s2, 3
  s_and_b32 s4, s6, 3
  s_lshl_b32 s4, s4, 3
  s_and_b32 s5, s7, 7
  s_add_u32 s4, s4, s5
  s_lshr_b32 s5, s6, 2
  s_lshl_b32 s5, s5, 2
  s_lshr_b32 s7, s7, 3
  s_add_u32 s5, s5, s7
  v_lshlrev_b32 v2, 4, v1
  v_and_b32 v3, 31, v1
  v_lshrrev_b32 v5, 5, v1
  s_lshl_b32 s6, s4, 6
  s_lshr_b32 s7, s3, 1
  s_lshl_b32 s7, s7, 5
  s_add_u32 s6, s6, s7
  v_add_u32 v6, s6, v3
  v_lshlrev_b32 v6, 10, v6
  v_lshl_add_u32 v6, v5, 3, v6
  s_lshl_b32 s7, s5, 7
  s_and_b32 s8, s3, 1
  s_lshl_b32 s8, s8, 6
  s_add_u32 s7, s7, s8
  v_add_u32 v6, s7, v6
  s_waitcnt lgkmcnt(0)
  s_add_u32 s8, s50, 0x400000
  s_addc_u32 s9, s51, 0
  s_mov_b32 s10, 0x700000
  s_mov_b32 s11, 0x20000
  s_add_u32 s12, s50, 0xb00000
  s_addc_u32 s13, s51, 0
  s_mov_b32 s14, 0x1c0000
  s_mov_b32 s15, 0x20000
  s_add_u32 s20, s50, 0x200000
  s_addc_u32 s21, s51, 0
  s_mov_b32 s22, 0x200000
  s_mov_b32 s23, 0x20000
  s_mov_b32 s24, s40
  s_mov_b32 s25, s41
  s_mov_b32 s26, 0x200000
  s_mov_b32 s27, 0x20000
  s_mul_i32 s32, s4, 224
  s_mul_i32 s6, s3, 28
  s_add_u32 s32, s32, s6
  s_lshl_b32 s32, s32, 10
  s_lshl_b32 s33, s6, 4
  s_lshl_b32 s7, s5, 1
  s_add_u32 s33, s33, s7
  s_lshl_b32 s33, s33, 10
  buffer_load_dwordx2 v[16:17], v6, s[20:23], 0 offen offset:0
  buffer_load_dwordx2 v[18:19], v6, s[20:23], 0 offen offset:16
  buffer_load_dwordx2 v[20:21], v6, s[20:23], 0 offen offset:32
  buffer_load_dwordx2 v[22:23], v6, s[20:23], 0 offen offset:48
  s_add_u32 s7, s32, 0
  buffer_load_dwordx4 v[32:35], v2, s[8:11], s7 offen
  s_add_u32 s7, s32, 114688
  buffer_load_dwordx4 v[36:39], v2, s[8:11], s7 offen
  s_add_u32 s7, s33, 0
  buffer_load_dwordx4 v[40:43], v2, s[12:15], s7 offen
  buffer_load_dwordx4 v[44:47], v2, s[12:15], s7 offen offset:1024
  s_add_u32 s7, s32, 1024
  buffer_load_dwordx4 v[48:51], v2, s[8:11], s7 offen
  s_add_u32 s7, s32, 115712
  buffer_load_dwordx4 v[52:55], v2, s[8:11], s7 offen
  s_add_u32 s7, s33, 16384
  buffer_load_dwordx4 v[56:59], v2, s[12:15], s7 offen
  buffer_load_dwordx4 v[60:63], v2, s[12:15], s7 offen offset:1024
  s_add_u32 s7, s32, 2048
  buffer_load_dwordx4 v[64:67], v2, s[8:11], s7 offen
  s_add_u32 s7, s32, 116736
  buffer_load_dwordx4 v[68:71], v2, s[8:11], s7 offen
  s_add_u32 s7, s33, 32768
  buffer_load_dwordx4 v[72:75], v2, s[12:15], s7 offen
  buffer_load_dwordx4 v[76:79], v2, s[12:15], s7 offen offset:1024
  s_add_u32 s7, s32, 3072
  buffer_load_dwordx4 v[80:83], v2, s[8:11], s7 offen
  s_add_u32 s7, s32, 117760
  buffer_load_dwordx4 v[84:87], v2, s[8:11], s7 offen
  s_add_u32 s7, s33, 49152
  buffer_load_dwordx4 v[88:91], v2, s[12:15], s7 offen
  buffer_load_dwordx4 v[92:95], v2, s[12:15], s7 offen offset:1024
  s_add_u32 s7, s32, 4096
  buffer_load_dwordx4 v[96:99], v2, s[8:11], s7 offen
  s_add_u32 s7, s32, 118784
  buffer_load_dwordx4 v[100:103], v2, s[8:11], s7 offen
  s_add_u32 s7, s33, 65536
  buffer_load_dwordx4 v[104:107], v2, s[12:15], s7 offen
  buffer_load_dwordx4 v[108:111], v2, s[12:15], s7 offen offset:1024
  s_add_u32 s7, s32, 5120
  buffer_load_dwordx4 v[112:115], v2, s[8:11], s7 offen
  s_add_u32 s7, s32, 119808
  buffer_load_dwordx4 v[116:119], v2, s[8:11], s7 offen
  s_add_u32 s7, s33, 81920
  buffer_load_dwordx4 v[120:123], v2, s[12:15], s7 offen
  buffer_load_dwordx4 v[124:127], v2, s[12:15], s7 offen offset:1024
  s_add_u32 s7, s32, 6144
  buffer_load_dwordx4 v[128:131], v2, s[8:11], s7 offen
  s_add_u32 s7, s32, 120832
  buffer_load_dwordx4 v[132:135], v2, s[8:11], s7 offen
  s_add_u32 s7, s33, 98304
  buffer_load_dwordx4 v[136:139], v2, s[12:15], s7 offen
  buffer_load_dwordx4 v[140:143], v2, s[12:15], s7 offen offset:1024
  s_add_u32 s7, s32, 7168
  buffer_load_dwordx4 v[144:147], v2, s[8:11], s7 offen
  s_add_u32 s7, s32, 121856
  buffer_load_dwordx4 v[148:151], v2, s[8:11], s7 offen
  s_add_u32 s7, s33, 114688
  buffer_load_dwordx4 v[152:155], v2, s[12:15], s7 offen
  buffer_load_dwordx4 v[156:159], v2, s[12:15], s7 offen offset:1024
  s_waitcnt vmcnt(28)
  v_mfma_f32_32x32x16_bf16 a[0:15], v[40:43], v[32:35], 0
  v_mfma_f32_32x32x16_bf16 a[16:31], v[44:47], v[32:35], 0
  v_mfma_f32_32x32x16_bf16 a[32:47], v[40:43], v[36:39], 0
  v_mfma_f32_32x32x16_bf16 a[48:63], v[44:47], v[36:39], 0
  s_add_u32 s7, s32, 8192
  buffer_load_dwordx4 v[32:35], v2, s[8:11], s7 offen
  s_add_u32 s7, s32, 122880
  buffer_load_dwordx4 v[36:39], v2, s[8:11], s7 offen
  s_add_u32 s7, s33, 131072
  buffer_load_dwordx4 v[40:43], v2, s[12:15], s7 offen
  buffer_load_dwordx4 v[44:47], v2, s[12:15], s7 offen offset:1024
  s_waitcnt vmcnt(28)
  v_mfma_f32_32x32x16_bf16 a[0:15], v[56:59], v[48:51], a[0:15]
  v_mfma_f32_32x32x16_bf16 a[16:31], v[60:63], v[48:51], a[16:31]
  v_mfma_f32_32x32x16_bf16 a[32:47], v[56:59], v[52:55], a[32:47]
  v_mfma_f32_32x32x16_bf16 a[48:63], v[60:63], v[52:55], a[48:63]
  s_add_u32 s7, s32, 9216
  buffer_load_dwordx4 v[48:51], v2, s[8:11], s7 offen
  s_add_u32 s7, s32, 123904
  buffer_load_dwordx4 v[52:55], v2, s[8:11], s7 offen
  s_add_u32 s7, s33, 147456
  buffer_load_dwordx4 v[56:59], v2, s[12:15], s7 offen
  buffer_load_dwordx4 v[60:63], v2, s[12:15], s7 offen offset:1024
  s_waitcnt vmcnt(28)
  v_mfma_f32_32x32x16_bf16 a[0:15], v[72:75], v[64:67], a[0:15]
  v_mfma_f32_32x32x16_bf16 a[16:31], v[76:79], v[64:67], a[16:31]
  v_mfma_f32_32x32x16_bf16 a[32:47], v[72:75], v[68:71], a[32:47]
  v_mfma_f32_32x32x16_bf16 a[48:63], v[76:79], v[68:71], a[48:63]
  s_add_u32 s7, s32, 10240
  buffer_load_dwordx4 v[64:67], v2, s[8:11], s7 offen
  s_add_u32 s7, s32, 124928
  buffer_load_dwordx4 v[68:71], v2, s[8:11], s7 offen
  s_add_u32 s7, s33, 163840
  buffer_load_dwordx4 v[72:75], v2, s[12:15], s7 offen
  buffer_load_dwordx4 v[76:79], v2, s[12:15], s7 offen offset:1024
  s_waitcnt vmcnt(28)
  v_mfma_f32_32x32x16_bf16 a[0:15], v[88:91], v[80:83], a[0:15]
  v_mfma_f32_32x32x16_bf16 a[16:31], v[92:95], v[80:83], a[16:31]
  v_mfma_f32_32x32x16_bf16 a[32:47], v[88:91], v[84:87], a[32:47]
  v_mfma_f32_32x32x16_bf16 a[48:63], v[92:95], v[84:87], a[48:63]
  s_add_u32 s7, s32, 11264
  buffer_load_dwordx4 v[80:83], v2, s[8:11], s7 offen
  s_add_u32 s7, s32, 125952
  buffer_load_dwordx4 v[84:87], v2, s[8:11], s7 offen
  s_add_u32 s7, s33, 180224
  buffer_load_dwordx4 v[88:91], v2, s[12:15], s7 offen
  buffer_load_dwordx4 v[92:95], v2, s[12:15], s7 offen offset:1024
  s_waitcnt vmcnt(28)
  v_mfma_f32_32x32x16_bf16 a[0:15], v[104:107], v[96:99], a[0:15]
  v_mfma_f32_32x32x16_bf16 a[16:31], v[108:111], v[96:99], a[16:31]
  v_mfma_f32_32x32x16_bf16 a[32:47], v[104:107], v[100:103], a[32:47]
  v_mfma_f32_32x32x16_bf16 a[48:63], v[108:111], v[100:103], a[48:63]
  s_add_u32 s7, s32, 12288
  buffer_load_dwordx4 v[96:99], v2, s[8:11], s7 offen
  s_add_u32 s7, s32, 126976
  buffer_load_dwordx4 v[100:103], v2, s[8:11], s7 offen
  s_add_u32 s7, s33, 196608
  buffer_load_dwordx4 v[104:107], v2, s[12:15], s7 offen
  buffer_load_dwordx4 v[108:111], v2, s[12:15], s7 offen offset:1024
  s_waitcnt vmcnt(28)
  v_mfma_f32_32x32x16_bf16 a[0:15], v[120:123], v[112:115], a[0:15]
  v_mfma_f32_32x32x16_bf16 a[16:31], v[124:127], v[112:115], a[16:31]
  v_mfma_f32_32x32x16_bf16 a[32:47], v[120:123], v[116:119], a[32:47]
  v_mfma_f32_32x32x16_bf16 a[48:63], v[124:127], v[116:119], a[48:63]
  s_add_u32 s7, s32, 13312
  buffer_load_dwordx4 v[112:115], v2, s[8:11], s7 offen
  s_add_u32 s7, s32, 128000
  buffer_load_dwordx4 v[116:119], v2, s[8:11], s7 offen
  s_add_u32 s7, s33, 212992
  buffer_load_dwordx4 v[120:123], v2, s[12:15], s7 offen
  buffer_load_dwordx4 v[124:127], v2, s[12:15], s7 offen offset:1024
  s_waitcnt vmcnt(28)
  v_mfma_f32_32x32x16_bf16 a[0:15], v[136:139], v[128:131], a[0:15]
  v_mfma_f32_32x32x16_bf16 a[16:31], v[140:143], v[128:131], a[16:31]
  v_mfma_f32_32x32x16_bf16 a[32:47], v[136:139], v[132:135], a[32:47]
  v_mfma_f32_32x32x16_bf16 a[48:63], v[140:143], v[132:135], a[48:63]
  s_add_u32 s7, s32, 14336
  buffer_load_dwordx4 v[128:131], v2, s[8:11], s7 offen
  s_add_u32 s7, s32, 129024
  buffer_load_dwordx4 v[132:135], v2, s[8:11], s7 offen
  s_add_u32 s7, s33, 229376
  buffer_load_dwordx4 v[136:139], v2, s[12:15], s7 offen
  buffer_load_dwordx4 v[140:143], v2, s[12:15], s7 offen offset:1024
  s_waitcnt vmcnt(28)
  v_mfma_f32_32x32x16_bf16 a[0:15], v[152:155], v[144:147], a[0:15]
  v_mfma_f32_32x32x16_bf16 a[16:31], v[156:159], v[144:147], a[16:31]
  v_mfma_f32_32x32x16_bf16 a[32:47], v[152:155], v[148:151], a[32:47]
  v_mfma_f32_32x32x16_bf16 a[48:63], v[156:159], v[148:151], a[48:63]
  s_add_u32 s7, s32, 15360
  buffer_load_dwordx4 v[144:147], v2, s[8:11], s7 offen
  s_add_u32 s7, s32, 130048
  buffer_load_dwordx4 v[148:151], v2, s[8:11], s7 offen
  s_add_u32 s7, s33, 245760
  buffer_load_dwordx4 v[152:155], v2, s[12:15], s7 offen
  buffer_load_dwordx4 v[156:159], v2, s[12:15], s7 offen offset:1024
  s_waitcnt vmcnt(28)
  v_mfma_f32_32x32x16_bf16 a[0:15], v[40:43], v[32:35], a[0:15]
  v_mfma_f32_32x32x16_bf16 a[16:31], v[44:47], v[32:35], a[16:31]
  v_mfma_f32_32x32x16_bf16 a[32:47], v[40:43], v[36:39], a[32:47]
  v_mfma_f32_32x32x16_bf16 a[48:63], v[44:47], v[36:39], a[48:63]
  s_add_u32 s7, s32, 16384
  buffer_load_dwordx4 v[32:35], v2, s[8:11], s7 offen
  s_add_u32 s7, s32, 131072
  buffer_load_dwordx4 v[36:39], v2, s[8:11], s7 offen
  s_add_u32 s7, s33, 262144
  buffer_load_dwordx4 v[40:43], v2, s[12:15], s7 offen
  buffer_load_dwordx4 v[44:47], v2, s[12:15], s7 offen offset:1024
  s_waitcnt vmcnt(28)
  v_mfma_f32_32x32x16_bf16 a[0:15], v[56:59], v[48:51], a[0:15]
  v_mfma_f32_32x32x16_bf16 a[16:31], v[60:63], v[48:51], a[16:31]
  v_mfma_f32_32x32x16_bf16 a[32:47], v[56:59], v[52:55], a[32:47]
  v_mfma_f32_32x32x16_bf16 a[48:63], v[60:63], v[52:55], a[48:63]
  s_add_u32 s7, s32, 17408
  buffer_load_dwordx4 v[48:51], v2, s[8:11], s7 offen
  s_add_u32 s7, s32, 132096
  buffer_load_dwordx4 v[52:55], v2, s[8:11], s7 offen
  s_add_u32 s7, s33, 278528
  buffer_load_dwordx4 v[56:59], v2, s[12:15], s7 offen
  buffer_load_dwordx4 v[60:63], v2, s[12:15], s7 offen offset:1024
  s_waitcnt vmcnt(28)
  v_mfma_f32_32x32x16_bf16 a[0:15], v[72:75], v[64:67], a[0:15]
  v_mfma_f32_32x32x16_bf16 a[16:31], v[76:79], v[64:67], a[16:31]
  v_mfma_f32_32x32x16_bf16 a[32:47], v[72:75], v[68:71], a[32:47]
  v_mfma_f32_32x32x16_bf16 a[48:63], v[76:79], v[68:71], a[48:63]
  s_add_u32 s7, s32, 18432
  buffer_load_dwordx4 v[64:67], v2, s[8:11], s7 offen
  s_add_u32 s7, s32, 133120
  buffer_load_dwordx4 v[68:71], v2, s[8:11], s7 offen
  s_add_u32 s7, s33, 294912
  buffer_load_dwordx4 v[72:75], v2, s[12:15], s7 offen
  buffer_load_dwordx4 v[76:79], v2, s[12:15], s7 offen offset:1024
  s_waitcnt vmcnt(28)
  v_mfma_f32_32x32x16_bf16 a[0:15], v[88:91], v[80:83], a[0:15]
  v_mfma_f32_32x32x16_bf16 a[16:31], v[92:95], v[80:83], a[16:31]
  v_mfma_f32_32x32x16_bf16 a[32:47], v[88:91], v[84:87], a[32:47]
  v_mfma_f32_32x32x16_bf16 a[48:63], v[92:95], v[84:87], a[48:63]
  s_add_u32 s7, s32, 19456
  buffer_load_dwordx4 v[80:83], v2, s[8:11], s7 offen
  s_add_u32 s7, s32, 134144
  buffer_load_dwordx4 v[84:87], v2, s[8:11], s7 offen
  s_add_u32 s7, s33, 311296
  buffer_load_dwordx4 v[88:91], v2, s[12:15], s7 offen
  buffer_load_dwordx4 v[92:95], v2, s[12:15], s7 offen offset:1024
  s_waitcnt vmcnt(28)
  v_mfma_f32_32x32x16_bf16 a[0:15], v[104:107], v[96:99], a[0:15]
  v_mfma_f32_32x32x16_bf16 a[16:31], v[108:111], v[96:99], a[16:31]
  v_mfma_f32_32x32x16_bf16 a[32:47], v[104:107], v[100:103], a[32:47]
  v_mfma_f32_32x32x16_bf16 a[48:63], v[108:111], v[100:103], a[48:63]
  s_add_u32 s7, s32, 20480
  buffer_load_dwordx4 v[96:99], v2, s[8:11], s7 offen
  s_add_u32 s7, s32, 135168
  buffer_load_dwordx4 v[100:103], v2, s[8:11], s7 offen
  s_add_u32 s7, s33, 327680
  buffer_load_dwordx4 v[104:107], v2, s[12:15], s7 offen
  buffer_load_dwordx4 v[108:111], v2, s[12:15], s7 offen offset:1024
  s_waitcnt vmcnt(28)
  v_mfma_f32_32x32x16_bf16 a[0:15], v[120:123], v[112:115], a[0:15]
  v_mfma_f32_32x32x16_bf16 a[16:31], v[124:127], v[112:115], a[16:31]
  v_mfma_f32_32x32x16_bf16 a[32:47], v[120:123], v[116:119], a[32:47]
  v_mfma_f32_32x32x16_bf16 a[48:63], v[124:127], v[116:119], a[48:63]
  s_add_u32 s7, s32, 21504
  buffer_load_dwordx4 v[112:115], v2, s[8:11], s7 offen
  s_add_u32 s7, s32, 136192
  buffer_load_dwordx4 v[116:119], v2, s[8:11], s7 offen
  s_add_u32 s7, s33, 344064
  buffer_load_dwordx4 v[120:123], v2, s[12:15], s7 offen
  buffer_load_dwordx4 v[124:127], v2, s[12:15], s7 offen offset:1024
  s_waitcnt vmcnt(28)
  v_mfma_f32_32x32x16_bf16 a[0:15], v[136:139], v[128:131], a[0:15]
  v_mfma_f32_32x32x16_bf16 a[16:31], v[140:143], v[128:131], a[16:31]
  v_mfma_f32_32x32x16_bf16 a[32:47], v[136:139], v[132:135], a[32:47]
  v_mfma_f32_32x32x16_bf16 a[48:63], v[140:143], v[132:135], a[48:63]
  s_add_u32 s7, s32, 22528
  buffer_load_dwordx4 v[128:131], v2, s[8:11], s7 offen
  s_add_u32 s7, s32, 137216
  buffer_load_dwordx4 v[132:135], v2, s[8:11], s7 offen
  s_add_u32 s7, s33, 360448
  buffer_load_dwordx4 v[136:139], v2, s[12:15], s7 offen
  buffer_load_dwordx4 v[140:143], v2, s[12:15], s7 offen offset:1024
  s_waitcnt vmcnt(28)
  v_mfma_f32_32x32x16_bf16 a[0:15], v[152:155], v[144:147], a[0:15]
  v_mfma_f32_32x32x16_bf16 a[16:31], v[156:159], v[144:147], a[16:31]
  v_mfma_f32_32x32x16_bf16 a[32:47], v[152:155], v[148:151], a[32:47]
  v_mfma_f32_32x32x16_bf16 a[48:63], v[156:159], v[148:151], a[48:63]
  s_add_u32 s7, s32, 23552
  buffer_load_dwordx4 v[144:147], v2, s[8:11], s7 offen
  s_add_u32 s7, s32, 138240
  buffer_load_dwordx4 v[148:151], v2, s[8:11], s7 offen
  s_add_u32 s7, s33, 376832
  buffer_load_dwordx4 v[152:155], v2, s[12:15], s7 offen
  buffer_load_dwordx4 v[156:159], v2, s[12:15], s7 offen offset:1024
  s_waitcnt vmcnt(28)
  v_mfma_f32_32x32x16_bf16 a[0:15], v[40:43], v[32:35], a[0:15]
  v_mfma_f32_32x32x16_bf16 a[16:31], v[44:47], v[32:35], a[16:31]
  v_mfma_f32_32x32x16_bf16 a[32:47], v[40:43], v[36:39], a[32:47]
  v_mfma_f32_32x32x16_bf16 a[48:63], v[44:47], v[36:39], a[48:63]
  s_add_u32 s7, s32, 24576
  buffer_load_dwordx4 v[32:35], v2, s[8:11], s7 offen
  s_add_u32 s7, s32, 139264
  buffer_load_dwordx4 v[36:39], v2, s[8:11], s7 offen
  s_add_u32 s7, s33, 393216
  buffer_load_dwordx4 v[40:43], v2, s[12:15], s7 offen
  buffer_load_dwordx4 v[44:47], v2, s[12:15], s7 offen offset:1024
  s_waitcnt vmcnt(28)
  v_mfma_f32_32x32x16_bf16 a[0:15], v[56:59], v[48:51], a[0:15]
  v_mfma_f32_32x32x16_bf16 a[16:31], v[60:63], v[48:51], a[16:31]
  v_mfma_f32_32x32x16_bf16 a[32:47], v[56:59], v[52:55], a[32:47]
  v_mfma_f32_32x32x16_bf16 a[48:63], v[60:63], v[52:55], a[48:63]
  s_add_u32 s7, s32, 25600
  buffer_load_dwordx4 v[48:51], v2, s[8:11], s7 offen
  s_add_u32 s7, s32, 140288
  buffer_load_dwordx4 v[52:55], v2, s[8:11], s7 offen
  s_add_u32 s7, s33, 409600
  buffer_load_dwordx4 v[56:59], v2, s[12:15], s7 offen
  buffer_load_dwordx4 v[60:63], v2, s[12:15], s7 offen offset:1024
  s_waitcnt vmcnt(28)
  v_mfma_f32_32x32x16_bf16 a[0:15], v[72:75], v[64:67], a[0:15]
  v_mfma_f32_32x32x16_bf16 a[16:31], v[76:79], v[64:67], a[16:31]
  v_mfma_f32_32x32x16_bf16 a[32:47], v[72:75], v[68:71], a[32:47]
  v_mfma_f32_32x32x16_bf16 a[48:63], v[76:79], v[68:71], a[48:63]
  s_add_u32 s7, s32, 26624
  buffer_load_dwordx4 v[64:67], v2, s[8:11], s7 offen
  s_add_u32 s7, s32, 141312
  buffer_load_dwordx4 v[68:71], v2, s[8:11], s7 offen
  s_add_u32 s7, s33, 425984
  buffer_load_dwordx4 v[72:75], v2, s[12:15], s7 offen
  buffer_load_dwordx4 v[76:79], v2, s[12:15], s7 offen offset:1024
  s_waitcnt vmcnt(28)
  v_mfma_f32_32x32x16_bf16 a[0:15], v[88:91], v[80:83], a[0:15]
  v_mfma_f32_32x32x16_bf16 a[16:31], v[92:95], v[80:83], a[16:31]
  v_mfma_f32_32x32x16_bf16 a[32:47], v[88:91], v[84:87], a[32:47]
  v_mfma_f32_32x32x16_bf16 a[48:63], v[92:95], v[84:87], a[48:63]
  s_add_u32 s7, s32, 27648
  buffer_load_dwordx4 v[80:83], v2, s[8:11], s7 offen
  s_add_u32 s7, s32, 142336
  buffer_load_dwordx4 v[84:87], v2, s[8:11], s7 offen
  s_add_u32 s7, s33, 442368
  buffer_load_dwordx4 v[88:91], v2, s[12:15], s7 offen
  buffer_load_dwordx4 v[92:95], v2, s[12:15], s7 offen offset:1024
  s_waitcnt vmcnt(28)
  v_mfma_f32_32x32x16_bf16 a[0:15], v[104:107], v[96:99], a[0:15]
  v_mfma_f32_32x32x16_bf16 a[16:31], v[108:111], v[96:99], a[16:31]
  v_mfma_f32_32x32x16_bf16 a[32:47], v[104:107], v[100:103], a[32:47]
  v_mfma_f32_32x32x16_bf16 a[48:63], v[108:111], v[100:103], a[48:63]
  s_waitcnt vmcnt(24)
  v_mfma_f32_32x32x16_bf16 a[0:15], v[120:123], v[112:115], a[0:15]
  v_mfma_f32_32x32x16_bf16 a[16:31], v[124:127], v[112:115], a[16:31]
  v_mfma_f32_32x32x16_bf16 a[32:47], v[120:123], v[116:119], a[32:47]
  v_mfma_f32_32x32x16_bf16 a[48:63], v[124:127], v[116:119], a[48:63]
  s_waitcnt vmcnt(20)
  v_mfma_f32_32x32x16_bf16 a[0:15], v[136:139], v[128:131], a[0:15]
  v_mfma_f32_32x32x16_bf16 a[16:31], v[140:143], v[128:131], a[16:31]
  v_mfma_f32_32x32x16_bf16 a[32:47], v[136:139], v[132:135], a[32:47]
  v_mfma_f32_32x32x16_bf16 a[48:63], v[140:143], v[132:135], a[48:63]
  s_waitcnt vmcnt(16)
  v_mfma_f32_32x32x16_bf16 a[0:15], v[152:155], v[144:147], a[0:15]
  v_mfma_f32_32x32x16_bf16 a[16:31], v[156:159], v[144:147], a[16:31]
  v_mfma_f32_32x32x16_bf16 a[32:47], v[152:155], v[148:151], a[32:47]
  v_mfma_f32_32x32x16_bf16 a[48:63], v[156:159], v[148:151], a[48:63]
  s_waitcnt vmcnt(12)
  v_mfma_f32_32x32x16_bf16 a[0:15], v[40:43], v[32:35], a[0:15]
  v_mfma_f32_32x32x16_bf16 a[16:31], v[44:47], v[32:35], a[16:31]
  v_mfma_f32_32x32x16_bf16 a[32:47], v[40:43], v[36:39], a[32:47]
  v_mfma_f32_32x32x16_bf16 a[48:63], v[44:47], v[36:39], a[48:63]
  s_waitcnt vmcnt(8)
  v_mfma_f32_32x32x16_bf16 a[0:15], v[56:59], v[48:51], a[0:15]
  v_mfma_f32_32x32x16_bf16 a[16:31], v[60:63], v[48:51], a[16:31]
  v_mfma_f32_32x32x16_bf16 a[32:47], v[56:59], v[52:55], a[32:47]
  v_mfma_f32_32x32x16_bf16 a[48:63], v[60:63], v[52:55], a[48:63]
  s_waitcnt vmcnt(4)
  v_mfma_f32_32x32x16_bf16 a[0:15], v[72:75], v[64:67], a[0:15]
  v_mfma_f32_32x32x16_bf16 a[16:31], v[76:79], v[64:67], a[16:31]
  v_mfma_f32_32x32x16_bf16 a[32:47], v[72:75], v[68:71], a[32:47]
  v_mfma_f32_32x32x16_bf16 a[48:63], v[76:79], v[68:71], a[48:63]
  s_waitcnt vmcnt(0)
  v_mfma_f32_32x32x16_bf16 a[0:15], v[88:91], v[80:83], a[0:15]
  v_mfma_f32_32x32x16_bf16 a[16:31], v[92:95], v[80:83], a[16:31]
  v_mfma_f32_32x32x16_bf16 a[32:47], v[88:91], v[84:87], a[32:47]
  v_mfma_f32_32x32x16_bf16 a[48:63], v[92:95], v[84:87], a[48:63]
  s_lshl_b32 s6, s3, 12
  v_add_u32 v3, s6, v2
  s_nop 15
  ds_write_b128 v3, a[0:3] offset:0
  ds_write_b128 v3, a[4:7] offset:1024
  ds_write_b128 v3, a[8:11] offset:2048
  ds_write_b128 v3, a[12:15] offset:3072
  ds_write_b128 v3, a[16:19] offset:16384
  ds_write_b128 v3, a[20:23] offset:17408
  ds_write_b128 v3, a[24:27] offset:18432
  ds_write_b128 v3, a[28:31] offset:19456
  ds_write_b128 v3, a[32:35] offset:32768
  ds_write_b128 v3, a[36:39] offset:33792
  ds_write_b128 v3, a[40:43] offset:34816
  ds_write_b128 v3, a[44:47] offset:35840
  ds_write_b128 v3, a[48:51] offset:49152
  ds_write_b128 v3, a[52:55] offset:50176
  ds_write_b128 v3, a[56:59] offset:51200
  ds_write_b128 v3, a[60:63] offset:52224
  s_waitcnt lgkmcnt(0)
  s_barrier
  s_lshl_b32 s6, s3, 14
  v_add_u32 v3, s6, v2
  ds_read_b128 v[32:35], v3 offset:0
  ds_read_b128 v[36:39], v3 offset:1024
  ds_read_b128 v[40:43], v3 offset:2048
  ds_read_b128 v[44:47], v3 offset:3072
  ds_read_b128 v[48:51], v3 offset:4096
  ds_read_b128 v[52:55], v3 offset:5120
  ds_read_b128 v[56:59], v3 offset:6144
  ds_read_b128 v[60:63], v3 offset:7168
  ds_read_b128 v[64:67], v3 offset:8192
  ds_read_b128 v[68:71], v3 offset:9216
  ds_read_b128 v[72:75], v3 offset:10240
  ds_read_b128 v[76:79], v3 offset:11264
  ds_read_b128 v[80:83], v3 offset:12288
  ds_read_b128 v[84:87], v3 offset:13312
  ds_read_b128 v[88:91], v3 offset:14336
  ds_read_b128 v[92:95], v3 offset:15360
  s_waitcnt lgkmcnt(0)
  v_add_f32 v32, v32, v48
  v_add_f32 v64, v64, v80
  v_add_f32 v32, v32, v64
  v_add_f32 v33, v33, v49
  v_add_f32 v65, v65, v81
  v_add_f32 v33, v33, v65
  v_add_f32 v34, v34, v50
  v_add_f32 v66, v66, v82
  v_add_f32 v34, v34, v66
  v_add_f32 v35, v35, v51
  v_add_f32 v67, v67, v83
  v_add_f32 v35, v35, v67
  v_add_f32 v36, v36, v52
  v_add_f32 v68, v68, v84
  v_add_f32 v36, v36, v68
  v_add_f32 v37, v37, v53
  v_add_f32 v69, v69, v85
  v_add_f32 v37, v37, v69
  v_add_f32 v38, v38, v54
  v_add_f32 v70, v70, v86
  v_add_f32 v38, v38, v70
  v_add_f32 v39, v39, v55
  v_add_f32 v71, v71, v87
  v_add_f32 v39, v39, v71
  v_add_f32 v40, v40, v56
  v_add_f32 v72, v72, v88
  v_add_f32 v40, v40, v72
  v_add_f32 v41, v41, v57
  v_add_f32 v73, v73, v89
  v_add_f32 v41, v41, v73
  v_add_f32 v42, v42, v58
  v_add_f32 v74, v74, v90
  v_add_f32 v42, v42, v74
  v_add_f32 v43, v43, v59
  v_add_f32 v75, v75, v91
  v_add_f32 v43, v43, v75
  v_add_f32 v44, v44, v60
  v_add_f32 v76, v76, v92
  v_add_f32 v44, v44, v76
  v_add_f32 v45, v45, v61
  v_add_f32 v77, v77, v93
  v_add_f32 v45, v45, v77
  v_add_f32 v46, v46, v62
  v_add_f32 v78, v78, v94
  v_add_f32 v46, v46, v78
  v_add_f32 v47, v47, v63
  v_add_f32 v79, v79, v95
  v_add_f32 v47, v47, v79
  v_cvt_pk_bf16_f32 v13, v32, v33
  v_lshlrev_b32 v14, 16, v13
  v_and_b32 v15, 0xffff0000, v13
  v_lshlrev_b32 v12, 16, v16
  v_and_b32 v11, 0xffff0000, v16
  v_add_f32 v14, v14, v12
  v_add_f32 v15, v15, v11
  v_cvt_pk_bf16_f32 v96, v14, v15
  v_cvt_pk_bf16_f32 v13, v34, v35
  v_lshlrev_b32 v14, 16, v13
  v_and_b32 v15, 0xffff0000, v13
  v_lshlrev_b32 v12, 16, v17
  v_and_b32 v11, 0xffff0000, v17
  v_add_f32 v14, v14, v12
  v_add_f32 v15, v15, v11
  v_cvt_pk_bf16_f32 v97, v14, v15
  buffer_store_dwordx2 v[96:97], v6, s[24:27], 0 offen offset:0
  v_cvt_pk_bf16_f32 v13, v36, v37
  v_lshlrev_b32 v14, 16, v13
  v_and_b32 v15, 0xffff0000, v13
  v_lshlrev_b32 v12, 16, v18
  v_and_b32 v11, 0xffff0000, v18
  v_add_f32 v14, v14, v12
  v_add_f32 v15, v15, v11
  v_cvt_pk_bf16_f32 v98, v14, v15
  v_cvt_pk_bf16_f32 v13, v38, v39
  v_lshlrev_b32 v14, 16, v13
  v_and_b32 v15, 0xffff0000, v13
  v_lshlrev_b32 v12, 16, v19
  v_and_b32 v11, 0xffff0000, v19
  v_add_f32 v14, v14, v12
  v_add_f32 v15, v15, v11
  v_cvt_pk_bf16_f32 v99, v14, v15
  buffer_store_dwordx2 v[98:99], v6, s[24:27], 0 offen offset:16
  v_cvt_pk_bf16_f32 v13, v40, v41
  v_lshlrev_b32 v14, 16, v13
  v_and_b32 v15, 0xffff0000, v13
  v_lshlrev_b32 v12, 16, v20
  v_and_b32 v11, 0xffff0000, v20
  v_add_f32 v14, v14, v12
  v_add_f32 v15, v15, v11
  v_cvt_pk_bf16_f32 v100, v14, v15
  v_cvt_pk_bf16_f32 v13, v42, v43
  v_lshlrev_b32 v14, 16, v13
  v_and_b32 v15, 0xffff0000, v13
  v_lshlrev_b32 v12, 16, v21
  v_and_b32 v11, 0xffff0000, v21
  v_add_f32 v14, v14, v12
  v_add_f32 v15, v15, v11
  v_cvt_pk_bf16_f32 v101, v14, v15
  buffer_store_dwordx2 v[100:101], v6, s[24:27], 0 offen offset:32
  v_cvt_pk_bf16_f32 v13, v44, v45
  v_lshlrev_b32 v14, 16, v13
  v_and_b32 v15, 0xffff0000, v13
  v_lshlrev_b32 v12, 16, v22
  v_and_b32 v11, 0xffff0000, v22
  v_add_f32 v14, v14, v12
  v_add_f32 v15, v15, v11
  v_cvt_pk_bf16_f32 v102, v14, v15
  v_cvt_pk_bf16_f32 v13, v46, v47
  v_lshlrev_b32 v14, 16, v13
  v_and_b32 v15, 0xffff0000, v13
  v_lshlrev_b32 v12, 16, v23
  v_and_b32 v11, 0xffff0000, v23
  v_add_f32 v14, v14, v12
  v_add_f32 v15, v15, v11
  v_cvt_pk_bf16_f32 v103, v14, v15
  buffer_store_dwordx2 v[102:103], v6, s[24:27], 0 offen offset:48
  s_endpgm
P4_END:
  s_endpgm
.section .rodata,"a"
.p2align 6
.amdhsa_kernel p1_kernel
  .amdhsa_next_free_vgpr 224
  .amdhsa_next_free_sgpr 102
  .amdhsa_accum_offset 224
  .amdhsa_group_segment_fixed_size 0
  .amdhsa_kernarg_size 72
  .amdhsa_user_sgpr_count 2
  .amdhsa_user_sgpr_kernarg_segment_ptr 1
  .amdhsa_system_sgpr_workgroup_id_x 1
.end_amdhsa_kernel
.p2align 6
.amdhsa_kernel p2_kernel
  .amdhsa_next_free_vgpr 320
  .amdhsa_next_free_sgpr 102
  .amdhsa_accum_offset 256
  .amdhsa_group_segment_fixed_size 0
  .amdhsa_kernarg_size 72
  .amdhsa_user_sgpr_count 2
  .amdhsa_user_sgpr_kernarg_segment_ptr 1
  .amdhsa_system_sgpr_workgroup_id_x 1
.end_amdhsa_kernel
.p2align 6
.amdhsa_kernel p3_kernel
  .amdhsa_next_free_vgpr 224
  .amdhsa_next_free_sgpr 102
  .amdhsa_accum_offset 224
  .amdhsa_group_segment_fixed_size 0
  .amdhsa_kernarg_size 72
  .amdhsa_user_sgpr_count 2
  .amdhsa_user_sgpr_kernarg_segment_ptr 1
  .amdhsa_system_sgpr_workgroup_id_x 1
.end_amdhsa_kernel
.p2align 6
.amdhsa_kernel p4_kernel
  .amdhsa_next_free_vgpr 320
  .amdhsa_next_free_sgpr 102
  .amdhsa_accum_offset 256
  .amdhsa_group_segment_fixed_size 0
  .amdhsa_kernarg_size 72
  .amdhsa_user_sgpr_count 2
  .amdhsa_user_sgpr_kernarg_segment_ptr 1
  .amdhsa_system_sgpr_workgroup_id_x 1
.end_amdhsa_kernel
```
